```python
import torch

def _softmax(x, axis=-1):
    return torch.softmax(x, dim=axis)
def _gelu(x):
    return torch.nn.functional.gelu(x, approximate="tanh")
def _silu(x):
    return torch.nn.functional.silu(x)
def _sigmoid(x):
    return torch.sigmoid(x)
def _layernorm(x, axis=-1, eps=1e-5):
    m = x.mean(dim=axis, keepdim=True)
    v = x.var(dim=axis, keepdim=True, unbiased=False)
    return (x - m) / torch.sqrt(v + eps)
def _scatter_add(tgt, idx, src, axis=0):
    return tgt.clone().index_add_(axis, idx, src)
def _segment_sum(src, seg, n):
    out = torch.zeros((n,) + src.shape[1:], dtype=src.dtype)
    return out.index_add_(0, seg, src)
def _pad(x, pw):
    flat = tuple(v for pair in reversed(pw) for v in pair)
    return torch.nn.functional.pad(x, flat)

kernel_name = 'concat_heads__ssm_conv_s5__linear_attn_block__prompt'

def setup_inputs():

    _w = (lambda a: (lambda t: t.to(torch.bfloat16) if t.is_floating_point() else t)(torch.as_tensor(a)))
    def _A_setup():
        B, S, D = 1, 2048, 448
        P = D
        Lambda_re = -0.5 * (lambda _x: torch.exp(torch.as_tensor(_x)))((lambda *s: torch.randn(*s, dtype=torch.bfloat16) * 0.2)(P))
        Lambda_im = (lambda *s: torch.randn(*s, dtype=torch.bfloat16) * 0.4)(P) * 1.0
        B_re = (lambda *s: torch.randn(*s, dtype=torch.bfloat16) * 0.2)(P, D) * (D ** -0.5)
        B_im = (lambda *s: torch.randn(*s, dtype=torch.bfloat16) * 0.2)(P, D) * (D ** -0.5)
        C_re = (lambda *s: torch.randn(*s, dtype=torch.bfloat16) * 0.2)(D, P) * (P ** -0.5)
        C_im = (lambda *s: torch.randn(*s, dtype=torch.bfloat16) * 0.2)(D, P) * (P ** -0.5)
        log_dt = (lambda *s: torch.randn(*s, dtype=torch.bfloat16) * 0.2)(P) * 0.3 - 2.0
        Dskip = (lambda *s: torch.randn(*s, dtype=torch.bfloat16) * 0.05)(D)
        return {
            "x": _w((lambda *s: torch.randn(*s, dtype=torch.bfloat16) * 0.05)(B, S, D)),
            "Lambda_re": _w(Lambda_re),
            "Lambda_im": _w(Lambda_im),
            "B_re": _w(B_re),
            "B_im": _w(B_im),
            "C_re": _w(C_re),
            "C_im": _w(C_im),
            "log_dt": _w(log_dt),
            "Dskip": _w(Dskip),
        }
    _A_in = _A_setup()

    def _B_setup():
        B, S, D = 1, 2048, 448
        return {
            "x": _w((lambda *s: torch.randn(*s, dtype=torch.bfloat16) * 0.05)(B, S, D)),
            "wqkv": _w((lambda *s: torch.randn(*s, dtype=torch.bfloat16) * 0.4)(D, 3 * D)),
            "wo": _w((lambda *s: torch.randn(*s, dtype=torch.bfloat16) * 0.05)(D, D)),
        }
    _B_in = _B_setup()

    return {
        "A_x": _A_in["x"],
        "A_Lambda_re": _A_in["Lambda_re"],
        "A_Lambda_im": _A_in["Lambda_im"],
        "A_B_re": _A_in["B_re"],
        "A_B_im": _A_in["B_im"],
        "A_C_re": _A_in["C_re"],
        "A_C_im": _A_in["C_im"],
        "A_log_dt": _A_in["log_dt"],
        "A_Dskip": _A_in["Dskip"],
        "B_x": _B_in["x"],
        "B_wqkv": _B_in["wqkv"],
        "B_wo": _B_in["wo"],
    }

def reference(A_x, A_Lambda_re, A_Lambda_im, A_B_re, A_B_im, A_C_re, A_C_im, A_log_dt, A_Dskip, B_x, B_wqkv, B_wo):
    def _A_ref(x, Lambda_re, Lambda_im, B_re, B_im, C_re, C_im, log_dt, Dskip):
        Bsz, L, H = x.shape
        Lam = Lambda_re + 1j * Lambda_im
        Bmat = B_re + 1j * B_im
        Cmat = C_re + 1j * C_im
        dt = torch.exp(log_dt)
        Lam_bar = torch.exp(dt * Lam)
        B_bar = ((Lam_bar - 1.0) / Lam)[:, None] * Bmat
        Bu = torch.einsum("bld,pd->blp", x + 0j, B_bar)
        h = torch.zeros_like(Bu[:, 0, :])
        hs = []
        for t in range(L):
            h = Lam_bar[None, :] * h + Bu[:, t, :]
            hs.append(h)
        hseq = torch.stack(hs, 1)
        y = 2.0 * torch.einsum("blp,dp->bld", hseq, Cmat).real + x * Dskip[None, None, :]
        return y

    def _B_ref(x, wqkv, wo):
        B, S, D = x.shape
        H = 16; Dh = D // H
        qkv = (lambda x, *d: x.permute(*d))((x @ wqkv).reshape(B, S, 3, H, Dh), 2, 0, 3, 1, 4)
        q, k, v = qkv[0], qkv[1], qkv[2]
        phi = lambda t: torch.where(t > 0, t + 1, torch.exp(t)) + 1e-6
        pq, pk = phi(q), phi(k)
        kv = torch.einsum("bhsd,bhse->bhde", pk, v)
        z = torch.einsum("bhsd->bhd", pk)
        num = torch.einsum("bhqd,bhde->bhqe", pq, kv)
        den = torch.einsum("bhqd,bhd->bhq", pq, z)[..., None] + 1e-6
        o = num / den
        return (lambda x, *d: x.permute(*d))(o, 0, 2, 1, 3).reshape(B, S, D) @ wo

    a = _A_ref(A_x, A_Lambda_re, A_Lambda_im, A_B_re, A_B_im, A_C_re, A_C_im, A_log_dt, A_Dskip)
    b = _B_ref(B_x, B_wqkv, B_wo)
    return torch.concatenate([a, b], axis=-1)
```

```asm
; @launch grid=(256,1,1) block=(256,1,1) lds=163840
.amdgcn_target "amdgcn-amd-amdhsa--gfx950"
.text
.globl concat_heads__ssm_conv_s5__linear_attn_block__prompt_kernel
.p2align 8
.type concat_heads__ssm_conv_s5__linear_attn_block__prompt_kernel,@function
concat_heads__ssm_conv_s5__linear_attn_block__prompt_kernel:
s_load_dwordx16 s[8:23], s[0:1], 0
s_load_dwordx8 s[24:31], s[0:1], 64
s_load_dwordx4 s[32:35], s[0:1], 96
s_load_dwordx2 s[36:37], s[0:1], 112
s_cmp_ge_u32 s2, 256
s_cbranch_scc1 L_exit
v_and_b32 v1, 63, v0
v_lshrrev_b32 v2, 6, v0
s_and_b32 s3, s2, 7
s_lshr_b32 s7, s2, 3
v_readfirstlane_b32 s4, v2
s_getpc_b64 s[38:39]
L_pc:
s_lshl_b32 s59, s7, 10
s_lshl_b32 s60, s4, 8
s_add_u32 s59, s59, s60
s_min_u32 s59, s59, L_codeend - L_pc - 256
v_lshlrev_b32 v2, 7, v1
v_add_u32 v2, s59, v2
s_mov_b64 exec, 3
global_load_dword v255, v2, s[38:39]
s_mov_b64 exec, -1
s_and_b32 s5, s3, 3
s_lshl_b32 s5, s5, 2
s_and_b32 s6, s7, 3
s_add_u32 s5, s5, s6
s_lshr_b32 s6, s7, 2
s_xor_b32 s3, s3, 4
s_cmp_lt_u32 s3, 4
s_cbranch_scc1 L_roleA
s_and_b32 s58, s4, 1
s_lshr_b32 s57, s4, 1
v_and_b32 v7, 31, v1
v_and_b32 v228, 7, v1
v_lshrrev_b32 v229, 4, v1
v_xor_b32 v230, v228, v229
v_lshlrev_b32 v230, 4, v230
v_xor_b32 v231, 64, v230
v_lshrrev_b32 v232, 3, v1
s_lshl_b32 s59, s4, 5
v_add_u32 v232, s59, v232
v_mul_u32_u24 v232, 896, v232
v_add_u32 v10, v232, v230
v_add_u32 v11, v232, v231
v_add_u32 v11, 6144, v11
v_add_u32 v12, v232, v230
v_add_u32 v12, 12288, v12
v_add_u32 v13, v232, v231
v_add_u32 v13, 18432, v13
v_mul_u32_u24 v232, 37, v1
v_lshrrev_b32 v232, 8, v232
v_mul_u32_u24 v233, 7, v232
v_sub_u32 v233, v1, v233
v_and_b32 v234, 3, v232
v_lshlrev_b32 v234, 2, v234
v_lshrrev_b32 v232, 2, v232
v_add_u32 v232, v232, v234
s_lshl_b32 s59, s4, 4
v_add_u32 v232, s59, v232
v_mul_u32_u24 v232, 2688, v232
v_lshl_add_u32 v14, v233, 4, v232
v_add_u32 v15, 4480, v14
s_mul_i32 s54, s5, 114688
s_mul_i32 s55, s6, 112
s_lshl_b32 s56, s4, 12
s_mul_i32 s66, s4, 1792
s_add_u32 s53, s5, s6
s_cmp_ge_u32 s53, 14
s_cselect_b32 s59, 14, 0
s_sub_u32 s53, s53, s59
s_cmp_ge_u32 s53, 7
s_cselect_b32 s59, 7, 0
s_sub_u32 s53, s53, s59
s_cmp_ge_u32 s53, 7
s_cselect_b32 s59, 7, 0
s_sub_u32 s53, s53, s59
v_mov_b32 v30, 0
s_waitcnt lgkmcnt(0)
s_mov_b32 s48, s36
s_and_b32 s49, s37, 0xffff
s_mov_b32 s50, 11534336
s_mov_b32 s51, 0x00020000
buffer_load_dword v250, v30, s[48:51], 0 offen offset:128 sc1
s_mov_b32 s40, s26
s_and_b32 s41, s27, 0xffff
s_mov_b32 s42, 1835008
s_mov_b32 s43, 0x00020000
s_mov_b32 s44, s28
s_and_b32 s45, s29, 0xffff
s_mov_b32 s46, 1204224
s_mov_b32 s47, 0x00020000
s_add_u32 m0, s56, 0
s_lshl_b32 s67, s53, 7
s_add_u32 s67, s67, s54
buffer_load_dwordx4 v10, s[40:43], s67 offen offset:0 lds
buffer_load_dwordx4 v11, s[40:43], s67 offen offset:1024 lds
buffer_load_dwordx4 v12, s[40:43], s67 offen offset:2048 lds
buffer_load_dwordx4 v13, s[40:43], s67 offen offset:3072 lds
s_add_u32 m0, s66, 114688
s_mul_i32 s67, s53, 172032
s_add_u32 s67, s67, s55
s_add_u32 s67, s67, 896
s_mov_b32 exec_hi, 0x00ffffff
buffer_load_dwordx4 v14, s[44:47], s67 offen lds
s_mov_b32 exec_hi, -1
s_mov_b32 exec_hi, 0x00ffffff
buffer_load_dwordx4 v15, s[44:47], s67 offen offset:896 lds
s_mov_b32 exec_hi, -1
s_add_u32 m0, s66, 121856
s_add_u32 s67, s67, 896
s_mov_b32 exec_hi, 0x00ffffff
buffer_load_dwordx4 v14, s[44:47], s67 offen lds
s_mov_b32 exec_hi, -1
s_mov_b32 exec_hi, 0x00ffffff
buffer_load_dwordx4 v15, s[44:47], s67 offen offset:896 lds
s_mov_b32 exec_hi, -1
s_add_u32 s53, s53, 1
s_cmp_ge_u32 s53, 7
s_cselect_b32 s60, 7, 0
s_sub_u32 s53, s53, s60
s_mov_b32 s68, s32
s_and_b32 s69, s33, 0xffff
s_mov_b32 s70, 7340032
s_mov_b32 s71, 0x00020000
v_lshrrev_b32 v232, 5, v1
v_bfe_u32 v233, v1, 1, 3
v_lshlrev_b32 v234, 7, v7
s_lshl_b32 s59, s57, 13
v_add_u32 v235, 0, v232
v_xor_b32 v235, v235, v233
v_lshl_add_u32 v235, v235, 4, v234
v_add_u32 v2, s59, v235
v_add_u32 v16, 0x10000, v2
v_add_u32 v235, 2, v232
v_xor_b32 v235, v235, v233
v_lshl_add_u32 v235, v235, 4, v234
v_add_u32 v3, s59, v235
v_add_u32 v17, 0x10000, v3
v_add_u32 v235, 4, v232
v_xor_b32 v235, v235, v233
v_lshl_add_u32 v235, v235, 4, v234
v_add_u32 v4, s59, v235
v_add_u32 v18, 0x10000, v4
v_add_u32 v235, 6, v232
v_xor_b32 v235, v235, v233
v_lshl_add_u32 v235, v235, 4, v234
v_add_u32 v5, s59, v235
v_add_u32 v19, 0x10000, v5
v_bfe_u32 v232, v1, 2, 2
v_lshlrev_b32 v232, 2, v232
v_lshrrev_b32 v233, 5, v1
v_lshl_add_u32 v232, v233, 1, v232
v_mul_u32_u24 v232, 112, v232
v_bfe_u32 v233, v1, 4, 1
v_lshl_add_u32 v232, v233, 5, v232
v_and_b32 v233, 3, v1
v_lshl_add_u32 v232, v233, 3, v232
s_mul_i32 s59, s58, 56
s_add_u32 s59, s59, 114688
v_add_u32 v6, s59, v232
s_mov_b32 s64, 0x3fb8aa3b
s_mov_b32 s65, 0x358637bd
s_mul_i32 s59, s7, 98
s_lshl_b32 s60, s4, 5
s_add_u32 s59, s59, s60
v_add_u32 v253, s59, v1
v_mul_u32_u24 v252, 9363, v253
v_lshrrev_b32 v252, 16, v252
v_mul_u32_u24 v251, 7, v252
v_sub_u32 v251, v253, v251
v_lshlrev_b32 v251, 7, v251
v_mul_u32_u24 v252, 2688, v252
v_add_u32 v252, v252, v251
v_lshlrev_b32 v253, 7, v253
s_mov_b32 s36, s30
s_and_b32 s37, s31, 0xffff
s_mov_b32 s38, 401408
s_mov_b32 s39, 0x00020000
s_add_u32 m0, s56, 16384
s_lshl_b32 s67, s53, 7
s_add_u32 s67, s67, s54
buffer_load_dwordx4 v10, s[40:43], s67 offen offset:0 lds
buffer_load_dwordx4 v11, s[40:43], s67 offen offset:1024 lds
buffer_load_dwordx4 v12, s[40:43], s67 offen offset:2048 lds
buffer_load_dwordx4 v13, s[40:43], s67 offen offset:3072 lds
s_add_u32 m0, s66, 129024
s_mul_i32 s67, s53, 172032
s_add_u32 s67, s67, s55
s_add_u32 s67, s67, 896
s_mov_b32 exec_hi, 0x00ffffff
buffer_load_dwordx4 v14, s[44:47], s67 offen lds
s_mov_b32 exec_hi, -1
s_mov_b32 exec_hi, 0x00ffffff
buffer_load_dwordx4 v15, s[44:47], s67 offen offset:896 lds
s_mov_b32 exec_hi, -1
s_add_u32 m0, s66, 136192
s_add_u32 s67, s67, 896
s_mov_b32 exec_hi, 0x00ffffff
buffer_load_dwordx4 v14, s[44:47], s67 offen lds
s_mov_b32 exec_hi, -1
s_mov_b32 exec_hi, 0x00ffffff
buffer_load_dwordx4 v15, s[44:47], s67 offen offset:896 lds
s_mov_b32 exec_hi, -1
s_add_u32 s53, s53, 1
s_cmp_ge_u32 s53, 7
s_cselect_b32 s60, 7, 0
s_sub_u32 s53, s53, s60
s_waitcnt vmcnt(8)
s_barrier
ds_read_b128 v[24:27], v2 offset:0
ds_read_b64_tr_b16 v[32:33], v6 offset:0
ds_read_b64_tr_b16 v[34:35], v6 offset:112
ds_read_b64_tr_b16 v[36:37], v6 offset:7168
ds_read_b64_tr_b16 v[38:39], v6 offset:7280
ds_read_b128 v[28:31], v2 offset:4096
s_waitcnt lgkmcnt(0)
v_mfma_f32_32x32x16_bf16 v[64:79], v[24:27], v[32:35], 0
ds_read_b128 v[40:43], v3 offset:0
ds_read_b64_tr_b16 v[48:49], v6 offset:1792
ds_read_b64_tr_b16 v[50:51], v6 offset:1904
v_mfma_f32_32x32x16_bf16 v[96:111], v[24:27], v[36:39], 0
ds_read_b64_tr_b16 v[52:53], v6 offset:8960
ds_read_b64_tr_b16 v[54:55], v6 offset:9072
ds_read_b128 v[44:47], v3 offset:4096
v_mfma_f32_32x32x16_bf16 v[80:95], v[28:31], v[32:35], 0
s_add_u32 m0, s56, 32768
s_lshl_b32 s67, s53, 7
s_add_u32 s67, s67, s54
buffer_load_dwordx4 v10, s[40:43], s67 offen offset:0 lds
buffer_load_dwordx4 v11, s[40:43], s67 offen offset:1024 lds
v_mfma_f32_32x32x16_bf16 v[112:127], v[28:31], v[36:39], 0
buffer_load_dwordx4 v12, s[40:43], s67 offen offset:2048 lds
s_waitcnt lgkmcnt(0)
v_mfma_f32_32x32x16_bf16 v[64:79], v[40:43], v[48:51], v[64:79]
ds_read_b128 v[24:27], v4 offset:0
ds_read_b64_tr_b16 v[32:33], v6 offset:3584
ds_read_b64_tr_b16 v[34:35], v6 offset:3696
v_mfma_f32_32x32x16_bf16 v[96:111], v[40:43], v[52:55], v[96:111]
ds_read_b64_tr_b16 v[36:37], v6 offset:10752
ds_read_b64_tr_b16 v[38:39], v6 offset:10864
ds_read_b128 v[28:31], v4 offset:4096
v_mfma_f32_32x32x16_bf16 v[80:95], v[44:47], v[48:51], v[80:95]
buffer_load_dwordx4 v13, s[40:43], s67 offen offset:3072 lds
s_add_u32 m0, s66, 143360
s_mul_i32 s67, s53, 172032
s_add_u32 s67, s67, s55
s_add_u32 s67, s67, 896
s_mov_b32 exec_hi, 0x00ffffff
buffer_load_dwordx4 v14, s[44:47], s67 offen lds
s_mov_b32 exec_hi, -1
v_mfma_f32_32x32x16_bf16 v[112:127], v[44:47], v[52:55], v[112:127]
s_mov_b32 exec_hi, 0x00ffffff
buffer_load_dwordx4 v15, s[44:47], s67 offen offset:896 lds
s_mov_b32 exec_hi, -1
s_waitcnt lgkmcnt(0)
v_mfma_f32_32x32x16_bf16 v[64:79], v[24:27], v[32:35], v[64:79]
ds_read_b128 v[40:43], v5 offset:0
ds_read_b64_tr_b16 v[48:49], v6 offset:5376
ds_read_b64_tr_b16 v[50:51], v6 offset:5488
v_mfma_f32_32x32x16_bf16 v[96:111], v[24:27], v[36:39], v[96:111]
ds_read_b64_tr_b16 v[52:53], v6 offset:12544
ds_read_b64_tr_b16 v[54:55], v6 offset:12656
ds_read_b128 v[44:47], v5 offset:4096
v_mfma_f32_32x32x16_bf16 v[80:95], v[28:31], v[32:35], v[80:95]
s_add_u32 m0, s66, 150528
s_add_u32 s67, s67, 896
s_mov_b32 exec_hi, 0x00ffffff
buffer_load_dwordx4 v14, s[44:47], s67 offen lds
s_mov_b32 exec_hi, -1
s_mov_b32 exec_hi, 0x00ffffff
buffer_load_dwordx4 v15, s[44:47], s67 offen offset:896 lds
s_mov_b32 exec_hi, -1
s_add_u32 s53, s53, 1
s_cmp_ge_u32 s53, 7
s_cselect_b32 s60, 7, 0
s_sub_u32 s53, s53, s60
v_mfma_f32_32x32x16_bf16 v[112:127], v[28:31], v[36:39], v[112:127]
v_readfirstlane_b32 s52, v250
s_nop 3
s_mul_i32 s52, s52, 2654435761
s_add_u32 s52, s52, 2135587861
s_waitcnt lgkmcnt(0)
s_waitcnt vmcnt(8)
s_barrier
v_mfma_f32_32x32x16_bf16 v[64:79], v[40:43], v[48:51], v[64:79]
ds_read_b128 v[24:27], v2 offset:16384
ds_read_b64_tr_b16 v[32:33], v6 offset:14336
ds_read_b64_tr_b16 v[34:35], v6 offset:14448
v_mfma_f32_32x32x16_bf16 v[96:111], v[40:43], v[52:55], v[96:111]
ds_read_b64_tr_b16 v[36:37], v6 offset:21504
ds_read_b64_tr_b16 v[38:39], v6 offset:21616
ds_read_b128 v[28:31], v2 offset:20480
v_mfma_f32_32x32x16_bf16 v[80:95], v[44:47], v[48:51], v[80:95]
s_add_u32 m0, s56, 49152
s_lshl_b32 s67, s53, 7
s_add_u32 s67, s67, s54
buffer_load_dwordx4 v10, s[40:43], s67 offen offset:0 lds
v_mfma_f32_32x32x16_bf16 v[112:127], v[44:47], v[52:55], v[112:127]
buffer_load_dwordx4 v11, s[40:43], s67 offen offset:1024 lds
s_waitcnt lgkmcnt(0)
v_mfma_f32_32x32x16_bf16 v[64:79], v[24:27], v[32:35], v[64:79]
ds_read_b128 v[40:43], v3 offset:16384
ds_read_b64_tr_b16 v[48:49], v6 offset:16128
ds_read_b64_tr_b16 v[50:51], v6 offset:16240
v_mfma_f32_32x32x16_bf16 v[96:111], v[24:27], v[36:39], v[96:111]
ds_read_b64_tr_b16 v[52:53], v6 offset:23296
ds_read_b64_tr_b16 v[54:55], v6 offset:23408
ds_read_b128 v[44:47], v3 offset:20480
v_mfma_f32_32x32x16_bf16 v[80:95], v[28:31], v[32:35], v[80:95]
buffer_load_dwordx4 v12, s[40:43], s67 offen offset:2048 lds
v_mfma_f32_32x32x16_bf16 v[112:127], v[28:31], v[36:39], v[112:127]
buffer_load_dwordx4 v13, s[40:43], s67 offen offset:3072 lds
s_waitcnt lgkmcnt(0)
v_mfma_f32_32x32x16_bf16 v[64:79], v[40:43], v[48:51], v[64:79]
ds_read_b128 v[24:27], v4 offset:16384
ds_read_b64_tr_b16 v[32:33], v6 offset:17920
ds_read_b64_tr_b16 v[34:35], v6 offset:18032
v_mfma_f32_32x32x16_bf16 v[96:111], v[40:43], v[52:55], v[96:111]
ds_read_b64_tr_b16 v[36:37], v6 offset:25088
ds_read_b64_tr_b16 v[38:39], v6 offset:25200
ds_read_b128 v[28:31], v4 offset:20480
v_mfma_f32_32x32x16_bf16 v[80:95], v[44:47], v[48:51], v[80:95]
s_add_u32 m0, s66, 114688
s_mul_i32 s67, s53, 172032
s_add_u32 s67, s67, s55
s_add_u32 s67, s67, 896
s_mov_b32 exec_hi, 0x00ffffff
buffer_load_dwordx4 v14, s[44:47], s67 offen lds
s_mov_b32 exec_hi, -1
v_mfma_f32_32x32x16_bf16 v[112:127], v[44:47], v[52:55], v[112:127]
s_mov_b32 exec_hi, 0x00ffffff
buffer_load_dwordx4 v15, s[44:47], s67 offen offset:896 lds
s_mov_b32 exec_hi, -1
s_waitcnt lgkmcnt(0)
v_mfma_f32_32x32x16_bf16 v[64:79], v[24:27], v[32:35], v[64:79]
ds_read_b128 v[40:43], v5 offset:16384
ds_read_b64_tr_b16 v[48:49], v6 offset:19712
ds_read_b64_tr_b16 v[50:51], v6 offset:19824
v_mfma_f32_32x32x16_bf16 v[96:111], v[24:27], v[36:39], v[96:111]
ds_read_b64_tr_b16 v[52:53], v6 offset:26880
ds_read_b64_tr_b16 v[54:55], v6 offset:26992
ds_read_b128 v[44:47], v5 offset:20480
v_mfma_f32_32x32x16_bf16 v[80:95], v[28:31], v[32:35], v[80:95]
s_add_u32 m0, s66, 121856
s_add_u32 s67, s67, 896
s_mov_b32 exec_hi, 0x00ffffff
buffer_load_dwordx4 v14, s[44:47], s67 offen lds
s_mov_b32 exec_hi, -1
v_mfma_f32_32x32x16_bf16 v[112:127], v[28:31], v[36:39], v[112:127]
s_mov_b32 exec_hi, 0x00ffffff
buffer_load_dwordx4 v15, s[44:47], s67 offen offset:896 lds
s_mov_b32 exec_hi, -1
s_add_u32 s53, s53, 1
s_cmp_ge_u32 s53, 7
s_cselect_b32 s60, 7, 0
s_sub_u32 s53, s53, s60
s_waitcnt lgkmcnt(0)
s_waitcnt vmcnt(8)
s_barrier
v_mfma_f32_32x32x16_bf16 v[64:79], v[40:43], v[48:51], v[64:79]
ds_read_b128 v[24:27], v2 offset:32768
ds_read_b64_tr_b16 v[32:33], v6 offset:28672
ds_read_b64_tr_b16 v[34:35], v6 offset:28784
v_mfma_f32_32x32x16_bf16 v[96:111], v[40:43], v[52:55], v[96:111]
ds_read_b64_tr_b16 v[36:37], v6 offset:35840
ds_read_b64_tr_b16 v[38:39], v6 offset:35952
ds_read_b128 v[28:31], v2 offset:36864
v_mfma_f32_32x32x16_bf16 v[80:95], v[44:47], v[48:51], v[80:95]
s_add_u32 m0, s56, 65536
s_lshl_b32 s67, s53, 7
s_add_u32 s67, s67, s54
buffer_load_dwordx4 v10, s[40:43], s67 offen offset:0 lds
v_mfma_f32_32x32x16_bf16 v[112:127], v[44:47], v[52:55], v[112:127]
buffer_load_dwordx4 v11, s[40:43], s67 offen offset:1024 lds
s_waitcnt lgkmcnt(0)
v_mfma_f32_32x32x16_bf16 v[64:79], v[24:27], v[32:35], v[64:79]
ds_read_b128 v[40:43], v3 offset:32768
ds_read_b64_tr_b16 v[48:49], v6 offset:30464
ds_read_b64_tr_b16 v[50:51], v6 offset:30576
v_mfma_f32_32x32x16_bf16 v[96:111], v[24:27], v[36:39], v[96:111]
ds_read_b64_tr_b16 v[52:53], v6 offset:37632
ds_read_b64_tr_b16 v[54:55], v6 offset:37744
ds_read_b128 v[44:47], v3 offset:36864
v_mfma_f32_32x32x16_bf16 v[80:95], v[28:31], v[32:35], v[80:95]
buffer_load_dwordx4 v12, s[40:43], s67 offen offset:2048 lds
v_mfma_f32_32x32x16_bf16 v[112:127], v[28:31], v[36:39], v[112:127]
buffer_load_dwordx4 v13, s[40:43], s67 offen offset:3072 lds
s_waitcnt lgkmcnt(0)
v_mfma_f32_32x32x16_bf16 v[64:79], v[40:43], v[48:51], v[64:79]
ds_read_b128 v[24:27], v4 offset:32768
ds_read_b64_tr_b16 v[32:33], v6 offset:32256
ds_read_b64_tr_b16 v[34:35], v6 offset:32368
v_mfma_f32_32x32x16_bf16 v[96:111], v[40:43], v[52:55], v[96:111]
ds_read_b64_tr_b16 v[36:37], v6 offset:39424
ds_read_b64_tr_b16 v[38:39], v6 offset:39536
ds_read_b128 v[28:31], v4 offset:36864
v_mfma_f32_32x32x16_bf16 v[80:95], v[44:47], v[48:51], v[80:95]
s_add_u32 m0, s66, 129024
s_mul_i32 s67, s53, 172032
s_add_u32 s67, s67, s55
s_add_u32 s67, s67, 896
s_mov_b32 exec_hi, 0x00ffffff
buffer_load_dwordx4 v14, s[44:47], s67 offen lds
s_mov_b32 exec_hi, -1
v_mfma_f32_32x32x16_bf16 v[112:127], v[44:47], v[52:55], v[112:127]
s_mov_b32 exec_hi, 0x00ffffff
buffer_load_dwordx4 v15, s[44:47], s67 offen offset:896 lds
s_mov_b32 exec_hi, -1
s_waitcnt lgkmcnt(0)
v_mfma_f32_32x32x16_bf16 v[64:79], v[24:27], v[32:35], v[64:79]
ds_read_b128 v[40:43], v5 offset:32768
ds_read_b64_tr_b16 v[48:49], v6 offset:34048
ds_read_b64_tr_b16 v[50:51], v6 offset:34160
v_mfma_f32_32x32x16_bf16 v[96:111], v[24:27], v[36:39], v[96:111]
ds_read_b64_tr_b16 v[52:53], v6 offset:41216
ds_read_b64_tr_b16 v[54:55], v6 offset:41328
ds_read_b128 v[44:47], v5 offset:36864
v_mfma_f32_32x32x16_bf16 v[80:95], v[28:31], v[32:35], v[80:95]
s_add_u32 m0, s66, 136192
s_add_u32 s67, s67, 896
s_mov_b32 exec_hi, 0x00ffffff
buffer_load_dwordx4 v14, s[44:47], s67 offen lds
s_mov_b32 exec_hi, -1
v_mfma_f32_32x32x16_bf16 v[112:127], v[28:31], v[36:39], v[112:127]
s_mov_b32 exec_hi, 0x00ffffff
buffer_load_dwordx4 v15, s[44:47], s67 offen offset:896 lds
s_mov_b32 exec_hi, -1
s_add_u32 s53, s53, 1
s_cmp_ge_u32 s53, 7
s_cselect_b32 s60, 7, 0
s_sub_u32 s53, s53, s60
s_waitcnt lgkmcnt(0)
s_waitcnt vmcnt(8)
s_barrier
v_mfma_f32_32x32x16_bf16 v[64:79], v[40:43], v[48:51], v[64:79]
ds_read_b128 v[24:27], v2 offset:49152
ds_read_b64_tr_b16 v[32:33], v6 offset:0
ds_read_b64_tr_b16 v[34:35], v6 offset:112
v_mfma_f32_32x32x16_bf16 v[96:111], v[40:43], v[52:55], v[96:111]
ds_read_b64_tr_b16 v[36:37], v6 offset:7168
ds_read_b64_tr_b16 v[38:39], v6 offset:7280
ds_read_b128 v[28:31], v2 offset:53248
v_mfma_f32_32x32x16_bf16 v[80:95], v[44:47], v[48:51], v[80:95]
s_add_u32 m0, s56, 81920
s_lshl_b32 s67, s53, 7
s_add_u32 s67, s67, s54
buffer_load_dwordx4 v10, s[40:43], s67 offen offset:0 lds
buffer_load_dwordx4 v11, s[40:43], s67 offen offset:1024 lds
v_mfma_f32_32x32x16_bf16 v[112:127], v[44:47], v[52:55], v[112:127]
s_mov_b32 exec_hi, 0
buffer_load_dword v254, v252, s[44:47], 0 offen
s_mov_b32 exec_hi, -1
s_waitcnt lgkmcnt(0)
v_mfma_f32_32x32x16_bf16 v[64:79], v[24:27], v[32:35], v[64:79]
ds_read_b128 v[40:43], v3 offset:49152
ds_read_b64_tr_b16 v[48:49], v6 offset:1792
ds_read_b64_tr_b16 v[50:51], v6 offset:1904
v_mfma_f32_32x32x16_bf16 v[96:111], v[24:27], v[36:39], v[96:111]
ds_read_b64_tr_b16 v[52:53], v6 offset:8960
ds_read_b64_tr_b16 v[54:55], v6 offset:9072
ds_read_b128 v[44:47], v3 offset:53248
v_mfma_f32_32x32x16_bf16 v[80:95], v[28:31], v[32:35], v[80:95]
buffer_load_dwordx4 v12, s[40:43], s67 offen offset:2048 lds
v_mfma_f32_32x32x16_bf16 v[112:127], v[28:31], v[36:39], v[112:127]
buffer_load_dwordx4 v13, s[40:43], s67 offen offset:3072 lds
s_waitcnt lgkmcnt(0)
v_mfma_f32_32x32x16_bf16 v[64:79], v[40:43], v[48:51], v[64:79]
ds_read_b128 v[24:27], v4 offset:49152
ds_read_b64_tr_b16 v[32:33], v6 offset:3584
ds_read_b64_tr_b16 v[34:35], v6 offset:3696
v_mfma_f32_32x32x16_bf16 v[96:111], v[40:43], v[52:55], v[96:111]
ds_read_b64_tr_b16 v[36:37], v6 offset:10752
ds_read_b64_tr_b16 v[38:39], v6 offset:10864
ds_read_b128 v[28:31], v4 offset:53248
v_mfma_f32_32x32x16_bf16 v[80:95], v[44:47], v[48:51], v[80:95]
s_add_u32 m0, s66, 143360
s_mul_i32 s67, s53, 172032
s_add_u32 s67, s67, s55
s_add_u32 s67, s67, 896
s_mov_b32 exec_hi, 0x00ffffff
buffer_load_dwordx4 v14, s[44:47], s67 offen lds
s_mov_b32 exec_hi, -1
v_mfma_f32_32x32x16_bf16 v[112:127], v[44:47], v[52:55], v[112:127]
s_mov_b32 exec_hi, 0x00ffffff
buffer_load_dwordx4 v15, s[44:47], s67 offen offset:896 lds
s_mov_b32 exec_hi, -1
s_waitcnt lgkmcnt(0)
v_mfma_f32_32x32x16_bf16 v[64:79], v[24:27], v[32:35], v[64:79]
ds_read_b128 v[40:43], v5 offset:49152
ds_read_b64_tr_b16 v[48:49], v6 offset:5376
ds_read_b64_tr_b16 v[50:51], v6 offset:5488
v_mfma_f32_32x32x16_bf16 v[96:111], v[24:27], v[36:39], v[96:111]
ds_read_b64_tr_b16 v[52:53], v6 offset:12544
ds_read_b64_tr_b16 v[54:55], v6 offset:12656
ds_read_b128 v[44:47], v5 offset:53248
v_mfma_f32_32x32x16_bf16 v[80:95], v[28:31], v[32:35], v[80:95]
s_add_u32 m0, s66, 150528
s_add_u32 s67, s67, 896
s_mov_b32 exec_hi, 0x00ffffff
buffer_load_dwordx4 v14, s[44:47], s67 offen lds
s_mov_b32 exec_hi, -1
v_mfma_f32_32x32x16_bf16 v[112:127], v[28:31], v[36:39], v[112:127]
s_mov_b32 exec_hi, 0x00ffffff
buffer_load_dwordx4 v15, s[44:47], s67 offen offset:896 lds
s_mov_b32 exec_hi, -1
s_add_u32 s53, s53, 1
s_cmp_ge_u32 s53, 7
s_cselect_b32 s60, 7, 0
s_sub_u32 s53, s53, s60
s_waitcnt lgkmcnt(0)
s_waitcnt vmcnt(9)
s_barrier
v_mfma_f32_32x32x16_bf16 v[64:79], v[40:43], v[48:51], v[64:79]
ds_read_b128 v[24:27], v16 offset:0
ds_read_b64_tr_b16 v[32:33], v6 offset:14336
ds_read_b64_tr_b16 v[34:35], v6 offset:14448
v_mfma_f32_32x32x16_bf16 v[96:111], v[40:43], v[52:55], v[96:111]
ds_read_b64_tr_b16 v[36:37], v6 offset:21504
ds_read_b64_tr_b16 v[38:39], v6 offset:21616
ds_read_b128 v[28:31], v16 offset:4096
v_mfma_f32_32x32x16_bf16 v[80:95], v[44:47], v[48:51], v[80:95]
s_add_u32 m0, s56, 98304
s_lshl_b32 s67, s53, 7
s_add_u32 s67, s67, s54
buffer_load_dwordx4 v10, s[40:43], s67 offen offset:0 lds
v_mfma_f32_32x32x16_bf16 v[112:127], v[44:47], v[52:55], v[112:127]
buffer_load_dwordx4 v11, s[40:43], s67 offen offset:1024 lds
s_waitcnt lgkmcnt(0)
v_mfma_f32_32x32x16_bf16 v[64:79], v[24:27], v[32:35], v[64:79]
ds_read_b128 v[40:43], v17 offset:0
ds_read_b64_tr_b16 v[48:49], v6 offset:16128
ds_read_b64_tr_b16 v[50:51], v6 offset:16240
v_mfma_f32_32x32x16_bf16 v[96:111], v[24:27], v[36:39], v[96:111]
ds_read_b64_tr_b16 v[52:53], v6 offset:23296
ds_read_b64_tr_b16 v[54:55], v6 offset:23408
ds_read_b128 v[44:47], v17 offset:4096
v_mfma_f32_32x32x16_bf16 v[80:95], v[28:31], v[32:35], v[80:95]
buffer_load_dwordx4 v12, s[40:43], s67 offen offset:2048 lds
v_mfma_f32_32x32x16_bf16 v[112:127], v[28:31], v[36:39], v[112:127]
buffer_load_dwordx4 v13, s[40:43], s67 offen offset:3072 lds
s_waitcnt lgkmcnt(0)
v_mfma_f32_32x32x16_bf16 v[64:79], v[40:43], v[48:51], v[64:79]
ds_read_b128 v[24:27], v18 offset:0
ds_read_b64_tr_b16 v[32:33], v6 offset:17920
ds_read_b64_tr_b16 v[34:35], v6 offset:18032
v_mfma_f32_32x32x16_bf16 v[96:111], v[40:43], v[52:55], v[96:111]
ds_read_b64_tr_b16 v[36:37], v6 offset:25088
ds_read_b64_tr_b16 v[38:39], v6 offset:25200
ds_read_b128 v[28:31], v18 offset:4096
v_mfma_f32_32x32x16_bf16 v[80:95], v[44:47], v[48:51], v[80:95]
s_add_u32 m0, s66, 114688
s_mul_i32 s67, s53, 172032
s_add_u32 s67, s67, s55
s_add_u32 s67, s67, 896
s_mov_b32 exec_hi, 0x00ffffff
buffer_load_dwordx4 v14, s[44:47], s67 offen lds
s_mov_b32 exec_hi, -1
v_mfma_f32_32x32x16_bf16 v[112:127], v[44:47], v[52:55], v[112:127]
s_mov_b32 exec_hi, 0x00ffffff
buffer_load_dwordx4 v15, s[44:47], s67 offen offset:896 lds
s_mov_b32 exec_hi, -1
s_waitcnt lgkmcnt(0)
v_mfma_f32_32x32x16_bf16 v[64:79], v[24:27], v[32:35], v[64:79]
ds_read_b128 v[40:43], v19 offset:0
ds_read_b64_tr_b16 v[48:49], v6 offset:19712
ds_read_b64_tr_b16 v[50:51], v6 offset:19824
v_mfma_f32_32x32x16_bf16 v[96:111], v[24:27], v[36:39], v[96:111]
ds_read_b64_tr_b16 v[52:53], v6 offset:26880
ds_read_b64_tr_b16 v[54:55], v6 offset:26992
ds_read_b128 v[44:47], v19 offset:4096
v_mfma_f32_32x32x16_bf16 v[80:95], v[28:31], v[32:35], v[80:95]
s_add_u32 m0, s66, 121856
s_add_u32 s67, s67, 896
s_mov_b32 exec_hi, 0x00ffffff
buffer_load_dwordx4 v14, s[44:47], s67 offen lds
s_mov_b32 exec_hi, -1
v_mfma_f32_32x32x16_bf16 v[112:127], v[28:31], v[36:39], v[112:127]
s_mov_b32 exec_hi, 0x00ffffff
buffer_load_dwordx4 v15, s[44:47], s67 offen offset:896 lds
s_mov_b32 exec_hi, -1
s_add_u32 s53, s53, 1
s_cmp_ge_u32 s53, 7
s_cselect_b32 s60, 7, 0
s_sub_u32 s53, s53, s60
s_waitcnt lgkmcnt(0)
s_waitcnt vmcnt(8)
s_barrier
v_mfma_f32_32x32x16_bf16 v[64:79], v[40:43], v[48:51], v[64:79]
ds_read_b128 v[24:27], v16 offset:16384
ds_read_b64_tr_b16 v[32:33], v6 offset:28672
ds_read_b64_tr_b16 v[34:35], v6 offset:28784
v_mfma_f32_32x32x16_bf16 v[96:111], v[40:43], v[52:55], v[96:111]
ds_read_b64_tr_b16 v[36:37], v6 offset:35840
ds_read_b64_tr_b16 v[38:39], v6 offset:35952
ds_read_b128 v[28:31], v16 offset:20480
v_mfma_f32_32x32x16_bf16 v[80:95], v[44:47], v[48:51], v[80:95]
s_mov_b32 exec_hi, 0
buffer_load_dword v254, v253, s[36:39], 0 offen
s_mov_b32 exec_hi, -1
v_mfma_f32_32x32x16_bf16 v[112:127], v[44:47], v[52:55], v[112:127]
s_add_u32 m0, s66, 129024
s_mul_i32 s67, s53, 172032
s_add_u32 s67, s67, s55
s_mov_b32 exec_hi, 0x00ffffff
buffer_load_dwordx4 v14, s[44:47], s67 offen lds
s_mov_b32 exec_hi, -1
s_waitcnt lgkmcnt(0)
v_mfma_f32_32x32x16_bf16 v[64:79], v[24:27], v[32:35], v[64:79]
ds_read_b128 v[40:43], v17 offset:16384
ds_read_b64_tr_b16 v[48:49], v6 offset:30464
ds_read_b64_tr_b16 v[50:51], v6 offset:30576
v_mfma_f32_32x32x16_bf16 v[96:111], v[24:27], v[36:39], v[96:111]
ds_read_b64_tr_b16 v[52:53], v6 offset:37632
ds_read_b64_tr_b16 v[54:55], v6 offset:37744
ds_read_b128 v[44:47], v17 offset:20480
v_mfma_f32_32x32x16_bf16 v[80:95], v[28:31], v[32:35], v[80:95]
s_mov_b32 exec_hi, 0x00ffffff
buffer_load_dwordx4 v15, s[44:47], s67 offen offset:896 lds
s_mov_b32 exec_hi, -1
s_add_u32 s53, s53, 1
s_cmp_ge_u32 s53, 7
s_cselect_b32 s60, 7, 0
s_sub_u32 s53, s53, s60
v_mfma_f32_32x32x16_bf16 v[112:127], v[28:31], v[36:39], v[112:127]
s_waitcnt lgkmcnt(0)
v_mfma_f32_32x32x16_bf16 v[64:79], v[40:43], v[48:51], v[64:79]
ds_read_b128 v[24:27], v18 offset:16384
ds_read_b64_tr_b16 v[32:33], v6 offset:32256
ds_read_b64_tr_b16 v[34:35], v6 offset:32368
v_mfma_f32_32x32x16_bf16 v[96:111], v[40:43], v[52:55], v[96:111]
ds_read_b64_tr_b16 v[36:37], v6 offset:39424
ds_read_b64_tr_b16 v[38:39], v6 offset:39536
ds_read_b128 v[28:31], v18 offset:20480
v_mfma_f32_32x32x16_bf16 v[80:95], v[44:47], v[48:51], v[80:95]
s_add_u32 m0, s66, 136192
s_mul_i32 s67, s53, 172032
s_add_u32 s67, s67, s55
s_mov_b32 exec_hi, 0x00ffffff
buffer_load_dwordx4 v14, s[44:47], s67 offen lds
s_mov_b32 exec_hi, -1
v_mfma_f32_32x32x16_bf16 v[112:127], v[44:47], v[52:55], v[112:127]
s_waitcnt lgkmcnt(0)
v_mfma_f32_32x32x16_bf16 v[64:79], v[24:27], v[32:35], v[64:79]
ds_read_b128 v[40:43], v19 offset:16384
ds_read_b64_tr_b16 v[48:49], v6 offset:34048
ds_read_b64_tr_b16 v[50:51], v6 offset:34160
v_mfma_f32_32x32x16_bf16 v[96:111], v[24:27], v[36:39], v[96:111]
ds_read_b64_tr_b16 v[52:53], v6 offset:41216
ds_read_b64_tr_b16 v[54:55], v6 offset:41328
ds_read_b128 v[44:47], v19 offset:20480
v_mfma_f32_32x32x16_bf16 v[80:95], v[28:31], v[32:35], v[80:95]
s_mov_b32 exec_hi, 0x00ffffff
buffer_load_dwordx4 v15, s[44:47], s67 offen offset:896 lds
s_mov_b32 exec_hi, -1
s_add_u32 s53, s53, 1
s_cmp_ge_u32 s53, 7
s_cselect_b32 s60, 7, 0
s_sub_u32 s53, s53, s60
v_mfma_f32_32x32x16_bf16 v[112:127], v[28:31], v[36:39], v[112:127]
s_waitcnt lgkmcnt(0)
s_waitcnt vmcnt(5)
s_barrier
v_mfma_f32_32x32x16_bf16 v[64:79], v[40:43], v[48:51], v[64:79]
ds_read_b128 v[24:27], v16 offset:32768
ds_read_b64_tr_b16 v[32:33], v6 offset:0
ds_read_b64_tr_b16 v[34:35], v6 offset:112
v_mfma_f32_32x32x16_bf16 v[96:111], v[40:43], v[52:55], v[96:111]
ds_read_b64_tr_b16 v[36:37], v6 offset:7168
ds_read_b64_tr_b16 v[38:39], v6 offset:7280
ds_read_b128 v[28:31], v16 offset:36864
v_mfma_f32_32x32x16_bf16 v[80:95], v[44:47], v[48:51], v[80:95]
v_mfma_f32_32x32x16_bf16 v[112:127], v[44:47], v[52:55], v[112:127]
s_waitcnt lgkmcnt(0)
v_mfma_f32_32x32x16_bf16 v[64:79], v[24:27], v[32:35], v[64:79]
ds_read_b128 v[40:43], v17 offset:32768
ds_read_b64_tr_b16 v[48:49], v6 offset:1792
ds_read_b64_tr_b16 v[50:51], v6 offset:1904
v_mfma_f32_32x32x16_bf16 v[96:111], v[24:27], v[36:39], v[96:111]
ds_read_b64_tr_b16 v[52:53], v6 offset:8960
ds_read_b64_tr_b16 v[54:55], v6 offset:9072
ds_read_b128 v[44:47], v17 offset:36864
v_mfma_f32_32x32x16_bf16 v[80:95], v[28:31], v[32:35], v[80:95]
s_add_u32 m0, s66, 143360
s_mul_i32 s67, s53, 172032
s_add_u32 s67, s67, s55
s_mov_b32 exec_hi, 0x00ffffff
buffer_load_dwordx4 v14, s[44:47], s67 offen lds
s_mov_b32 exec_hi, -1
v_mfma_f32_32x32x16_bf16 v[112:127], v[28:31], v[36:39], v[112:127]
s_waitcnt lgkmcnt(0)
v_mfma_f32_32x32x16_bf16 v[64:79], v[40:43], v[48:51], v[64:79]
ds_read_b128 v[24:27], v18 offset:32768
ds_read_b64_tr_b16 v[32:33], v6 offset:3584
ds_read_b64_tr_b16 v[34:35], v6 offset:3696
v_mfma_f32_32x32x16_bf16 v[96:111], v[40:43], v[52:55], v[96:111]
ds_read_b64_tr_b16 v[36:37], v6 offset:10752
ds_read_b64_tr_b16 v[38:39], v6 offset:10864
ds_read_b128 v[28:31], v18 offset:36864
v_mfma_f32_32x32x16_bf16 v[80:95], v[44:47], v[48:51], v[80:95]
s_mov_b32 exec_hi, 0x00ffffff
buffer_load_dwordx4 v15, s[44:47], s67 offen offset:896 lds
s_mov_b32 exec_hi, -1
s_add_u32 s53, s53, 1
s_cmp_ge_u32 s53, 7
s_cselect_b32 s60, 7, 0
s_sub_u32 s53, s53, s60
v_mfma_f32_32x32x16_bf16 v[112:127], v[44:47], v[52:55], v[112:127]
s_waitcnt lgkmcnt(0)
v_mfma_f32_32x32x16_bf16 v[64:79], v[24:27], v[32:35], v[64:79]
ds_read_b128 v[40:43], v19 offset:32768
ds_read_b64_tr_b16 v[48:49], v6 offset:5376
ds_read_b64_tr_b16 v[50:51], v6 offset:5488
v_mfma_f32_32x32x16_bf16 v[96:111], v[24:27], v[36:39], v[96:111]
ds_read_b64_tr_b16 v[52:53], v6 offset:12544
ds_read_b64_tr_b16 v[54:55], v6 offset:12656
ds_read_b128 v[44:47], v19 offset:36864
v_mfma_f32_32x32x16_bf16 v[80:95], v[28:31], v[32:35], v[80:95]
v_mfma_f32_32x32x16_bf16 v[112:127], v[28:31], v[36:39], v[112:127]
s_waitcnt lgkmcnt(0)
v_mfma_f32_32x32x16_bf16 v[64:79], v[40:43], v[48:51], v[64:79]
v_mfma_f32_32x32x16_bf16 v[96:111], v[40:43], v[52:55], v[96:111]
v_mfma_f32_32x32x16_bf16 v[80:95], v[44:47], v[48:51], v[80:95]
v_mfma_f32_32x32x16_bf16 v[112:127], v[44:47], v[52:55], v[112:127]
s_barrier
s_nop 7
v_cmp_eq_u32 vcc, 28, v7
v_mov_b32 v228, 0x3f803f80
v_cvt_pk_bf16_f32 v40, v96, v97
v_cvt_pk_bf16_f32 v41, v98, v99
v_cvt_pk_bf16_f32 v42, v100, v101
v_cvt_pk_bf16_f32 v43, v102, v103
v_cvt_pk_bf16_f32 v44, v104, v105
v_cvt_pk_bf16_f32 v45, v106, v107
v_cvt_pk_bf16_f32 v46, v108, v109
v_cvt_pk_bf16_f32 v47, v110, v111
v_cndmask_b32 v40, v40, v228, vcc
v_cndmask_b32 v41, v41, v228, vcc
v_cndmask_b32 v42, v42, v228, vcc
v_cndmask_b32 v43, v43, v228, vcc
v_cndmask_b32 v44, v44, v228, vcc
v_cndmask_b32 v45, v45, v228, vcc
v_cndmask_b32 v46, v46, v228, vcc
v_cndmask_b32 v47, v47, v228, vcc
v_cvt_pk_bf16_f32 v48, v112, v113
v_cvt_pk_bf16_f32 v49, v114, v115
v_cvt_pk_bf16_f32 v50, v116, v117
v_cvt_pk_bf16_f32 v51, v118, v119
v_cvt_pk_bf16_f32 v52, v120, v121
v_cvt_pk_bf16_f32 v53, v122, v123
v_cvt_pk_bf16_f32 v54, v124, v125
v_cvt_pk_bf16_f32 v55, v126, v127
v_cndmask_b32 v48, v48, v228, vcc
v_cndmask_b32 v49, v49, v228, vcc
v_cndmask_b32 v50, v50, v228, vcc
v_cndmask_b32 v51, v51, v228, vcc
v_cndmask_b32 v52, v52, v228, vcc
v_cndmask_b32 v53, v53, v228, vcc
v_cndmask_b32 v54, v54, v228, vcc
v_cndmask_b32 v55, v55, v228, vcc
v_pk_mul_f32 v[224:225], v[64:65], s[64:65] op_sel_hi:[1,0]
v_pk_mul_f32 v[226:227], v[66:67], s[64:65] op_sel_hi:[1,0]
v_exp_f32_e64 v224, v224 clamp
v_exp_f32_e64 v225, v225 clamp
v_exp_f32_e64 v226, v226 clamp
v_exp_f32_e64 v227, v227 clamp
v_max_f32 v64, 0, v64
v_max_f32 v65, 0, v65
v_max_f32 v66, 0, v66
v_max_f32 v67, 0, v67
v_pk_add_f32 v[224:225], v[224:225], s[64:65] op_sel:[0,1] op_sel_hi:[1,1]
v_pk_add_f32 v[226:227], v[226:227], s[64:65] op_sel:[0,1] op_sel_hi:[1,1]
v_pk_add_f32 v[64:65], v[64:65], v[224:225]
v_pk_add_f32 v[66:67], v[66:67], v[226:227]
s_add_u32 m0, s66, 114688
s_mul_i32 s67, s53, 172032
s_add_u32 s67, s67, s55
s_mov_b32 exec_hi, 0x00ffffff
buffer_load_dwordx4 v14, s[44:47], s67 offen lds
s_mov_b32 exec_hi, -1
v_pk_mul_f32 v[224:225], v[68:69], s[64:65] op_sel_hi:[1,0]
v_pk_mul_f32 v[226:227], v[70:71], s[64:65] op_sel_hi:[1,0]
v_exp_f32_e64 v224, v224 clamp
v_exp_f32_e64 v225, v225 clamp
v_exp_f32_e64 v226, v226 clamp
v_exp_f32_e64 v227, v227 clamp
v_max_f32 v68, 0, v68
v_max_f32 v69, 0, v69
v_max_f32 v70, 0, v70
v_max_f32 v71, 0, v71
v_pk_add_f32 v[224:225], v[224:225], s[64:65] op_sel:[0,1] op_sel_hi:[1,1]
v_pk_add_f32 v[226:227], v[226:227], s[64:65] op_sel:[0,1] op_sel_hi:[1,1]
v_pk_add_f32 v[68:69], v[68:69], v[224:225]
v_pk_add_f32 v[70:71], v[70:71], v[226:227]
v_pk_mul_f32 v[224:225], v[72:73], s[64:65] op_sel_hi:[1,0]
v_pk_mul_f32 v[226:227], v[74:75], s[64:65] op_sel_hi:[1,0]
v_exp_f32_e64 v224, v224 clamp
v_exp_f32_e64 v225, v225 clamp
v_exp_f32_e64 v226, v226 clamp
v_exp_f32_e64 v227, v227 clamp
v_max_f32 v72, 0, v72
v_max_f32 v73, 0, v73
v_max_f32 v74, 0, v74
v_max_f32 v75, 0, v75
v_pk_add_f32 v[224:225], v[224:225], s[64:65] op_sel:[0,1] op_sel_hi:[1,1]
v_pk_add_f32 v[226:227], v[226:227], s[64:65] op_sel:[0,1] op_sel_hi:[1,1]
v_pk_add_f32 v[72:73], v[72:73], v[224:225]
v_pk_add_f32 v[74:75], v[74:75], v[226:227]
s_mov_b32 exec_hi, 0x00ffffff
buffer_load_dwordx4 v15, s[44:47], s67 offen offset:896 lds
s_mov_b32 exec_hi, -1
s_add_u32 s53, s53, 1
s_cmp_ge_u32 s53, 7
s_cselect_b32 s60, 7, 0
s_sub_u32 s53, s53, s60
v_pk_mul_f32 v[224:225], v[76:77], s[64:65] op_sel_hi:[1,0]
v_pk_mul_f32 v[226:227], v[78:79], s[64:65] op_sel_hi:[1,0]
v_exp_f32_e64 v224, v224 clamp
v_exp_f32_e64 v225, v225 clamp
v_exp_f32_e64 v226, v226 clamp
v_exp_f32_e64 v227, v227 clamp
v_max_f32 v76, 0, v76
v_max_f32 v77, 0, v77
v_max_f32 v78, 0, v78
v_max_f32 v79, 0, v79
v_pk_add_f32 v[224:225], v[224:225], s[64:65] op_sel:[0,1] op_sel_hi:[1,1]
v_pk_add_f32 v[226:227], v[226:227], s[64:65] op_sel:[0,1] op_sel_hi:[1,1]
v_pk_add_f32 v[76:77], v[76:77], v[224:225]
v_pk_add_f32 v[78:79], v[78:79], v[226:227]
v_cvt_pk_bf16_f32 v24, v64, v65
v_cvt_pk_bf16_f32 v25, v66, v67
v_cvt_pk_bf16_f32 v26, v68, v69
v_cvt_pk_bf16_f32 v27, v70, v71
v_cvt_pk_bf16_f32 v28, v72, v73
v_cvt_pk_bf16_f32 v29, v74, v75
v_cvt_pk_bf16_f32 v30, v76, v77
v_cvt_pk_bf16_f32 v31, v78, v79
s_nop 1
v_mfma_f32_32x32x16_bf16 v[96:111], v[24:27], v[40:43], 0
v_mfma_f32_32x32x16_bf16 v[96:111], v[28:31], v[44:47], v[96:111]
v_pk_mul_f32 v[224:225], v[80:81], s[64:65] op_sel_hi:[1,0]
v_pk_mul_f32 v[226:227], v[82:83], s[64:65] op_sel_hi:[1,0]
v_exp_f32_e64 v224, v224 clamp
v_exp_f32_e64 v225, v225 clamp
v_exp_f32_e64 v226, v226 clamp
v_exp_f32_e64 v227, v227 clamp
v_max_f32 v80, 0, v80
v_max_f32 v81, 0, v81
v_max_f32 v82, 0, v82
v_max_f32 v83, 0, v83
v_pk_add_f32 v[224:225], v[224:225], s[64:65] op_sel:[0,1] op_sel_hi:[1,1]
v_pk_add_f32 v[226:227], v[226:227], s[64:65] op_sel:[0,1] op_sel_hi:[1,1]
v_pk_add_f32 v[80:81], v[80:81], v[224:225]
v_pk_add_f32 v[82:83], v[82:83], v[226:227]
s_add_u32 m0, s66, 121856
s_mul_i32 s67, s53, 172032
s_add_u32 s67, s67, s55
s_mov_b32 exec_hi, 0x00ffffff
buffer_load_dwordx4 v14, s[44:47], s67 offen lds
s_mov_b32 exec_hi, -1
v_pk_mul_f32 v[224:225], v[84:85], s[64:65] op_sel_hi:[1,0]
v_pk_mul_f32 v[226:227], v[86:87], s[64:65] op_sel_hi:[1,0]
v_exp_f32_e64 v224, v224 clamp
v_exp_f32_e64 v225, v225 clamp
v_exp_f32_e64 v226, v226 clamp
v_exp_f32_e64 v227, v227 clamp
v_max_f32 v84, 0, v84
v_max_f32 v85, 0, v85
v_max_f32 v86, 0, v86
v_max_f32 v87, 0, v87
v_pk_add_f32 v[224:225], v[224:225], s[64:65] op_sel:[0,1] op_sel_hi:[1,1]
v_pk_add_f32 v[226:227], v[226:227], s[64:65] op_sel:[0,1] op_sel_hi:[1,1]
v_pk_add_f32 v[84:85], v[84:85], v[224:225]
v_pk_add_f32 v[86:87], v[86:87], v[226:227]
v_pk_mul_f32 v[224:225], v[88:89], s[64:65] op_sel_hi:[1,0]
v_pk_mul_f32 v[226:227], v[90:91], s[64:65] op_sel_hi:[1,0]
v_exp_f32_e64 v224, v224 clamp
v_exp_f32_e64 v225, v225 clamp
v_exp_f32_e64 v226, v226 clamp
v_exp_f32_e64 v227, v227 clamp
v_max_f32 v88, 0, v88
v_max_f32 v89, 0, v89
v_max_f32 v90, 0, v90
v_max_f32 v91, 0, v91
v_pk_add_f32 v[224:225], v[224:225], s[64:65] op_sel:[0,1] op_sel_hi:[1,1]
v_pk_add_f32 v[226:227], v[226:227], s[64:65] op_sel:[0,1] op_sel_hi:[1,1]
v_pk_add_f32 v[88:89], v[88:89], v[224:225]
v_pk_add_f32 v[90:91], v[90:91], v[226:227]
s_mov_b32 exec_hi, 0x00ffffff
buffer_load_dwordx4 v15, s[44:47], s67 offen offset:896 lds
s_mov_b32 exec_hi, -1
s_add_u32 s53, s53, 1
s_cmp_ge_u32 s53, 7
s_cselect_b32 s60, 7, 0
s_sub_u32 s53, s53, s60
v_pk_mul_f32 v[224:225], v[92:93], s[64:65] op_sel_hi:[1,0]
v_pk_mul_f32 v[226:227], v[94:95], s[64:65] op_sel_hi:[1,0]
v_exp_f32_e64 v224, v224 clamp
v_exp_f32_e64 v225, v225 clamp
v_exp_f32_e64 v226, v226 clamp
v_exp_f32_e64 v227, v227 clamp
v_max_f32 v92, 0, v92
v_max_f32 v93, 0, v93
v_max_f32 v94, 0, v94
v_max_f32 v95, 0, v95
v_pk_add_f32 v[224:225], v[224:225], s[64:65] op_sel:[0,1] op_sel_hi:[1,1]
v_pk_add_f32 v[226:227], v[226:227], s[64:65] op_sel:[0,1] op_sel_hi:[1,1]
v_pk_add_f32 v[92:93], v[92:93], v[224:225]
v_pk_add_f32 v[94:95], v[94:95], v[226:227]
v_cvt_pk_bf16_f32 v32, v80, v81
v_cvt_pk_bf16_f32 v33, v82, v83
v_cvt_pk_bf16_f32 v34, v84, v85
v_cvt_pk_bf16_f32 v35, v86, v87
v_cvt_pk_bf16_f32 v36, v88, v89
v_cvt_pk_bf16_f32 v37, v90, v91
v_cvt_pk_bf16_f32 v38, v92, v93
v_cvt_pk_bf16_f32 v39, v94, v95
s_nop 1
v_mfma_f32_32x32x16_bf16 v[96:111], v[32:35], v[48:51], v[96:111]
v_mfma_f32_32x32x16_bf16 v[96:111], v[36:39], v[52:55], v[96:111]
v_mov_b32 v161, s52
v_mov_b32 v163, s52
v_mov_b32 v165, s52
v_mov_b32 v167, s52
v_mov_b32 v169, s52
v_mov_b32 v171, s52
v_mov_b32 v173, s52
v_mov_b32 v175, s52
v_lshlrev_b32 v225, 4, v1
s_lshl_b32 s59, s58, 12
s_add_u32 s59, s59, 155648
v_add_u32 v226, s59, v225
s_lshl_b32 s61, s6, 4
s_add_u32 s61, s61, s5
s_lshl_b32 s61, s61, 1
s_add_u32 s61, s61, s58
s_lshl_b32 s61, s61, 13
s_add_u32 s61, s61, 262144
s_waitcnt vmcnt(0)
s_nop 1
s_cmp_eq_u32 s57, 0
s_cbranch_scc0 L_kvx1_1
ds_write_b128 v226, v[104:107] offset:0
ds_write_b128 v226, v[108:111] offset:1024
s_waitcnt lgkmcnt(0)
s_barrier
ds_read_b128 v[228:231], v226 offset:2048
ds_read_b128 v[232:235], v226 offset:3072
s_waitcnt lgkmcnt(0)
v_add_f32 v160, v96, v228
v_add_f32 v162, v97, v229
v_add_f32 v164, v98, v230
v_add_f32 v166, v99, v231
v_add_f32 v168, v100, v232
v_add_f32 v170, v101, v233
v_add_f32 v172, v102, v234
v_add_f32 v174, v103, v235
buffer_store_dwordx4 v[160:163], v225, s[48:51], s61 offen offset:0 sc1
buffer_store_dwordx4 v[164:167], v225, s[48:51], s61 offen offset:1024 sc1
buffer_store_dwordx4 v[168:171], v225, s[48:51], s61 offen offset:2048 sc1
buffer_store_dwordx4 v[172:175], v225, s[48:51], s61 offen offset:3072 sc1
s_branch L_kvxd_2
L_kvx1_1:
ds_write_b128 v226, v[96:99] offset:2048
ds_write_b128 v226, v[100:103] offset:3072
s_waitcnt lgkmcnt(0)
s_barrier
ds_read_b128 v[228:231], v226 offset:0
ds_read_b128 v[232:235], v226 offset:1024
s_waitcnt lgkmcnt(0)
v_add_f32 v160, v104, v228
v_add_f32 v162, v105, v229
v_add_f32 v164, v106, v230
v_add_f32 v166, v107, v231
v_add_f32 v168, v108, v232
v_add_f32 v170, v109, v233
v_add_f32 v172, v110, v234
v_add_f32 v174, v111, v235
s_add_u32 s61, s61, 4096
buffer_store_dwordx4 v[160:163], v225, s[48:51], s61 offen offset:0 sc1
buffer_store_dwordx4 v[164:167], v225, s[48:51], s61 offen offset:1024 sc1
buffer_store_dwordx4 v[168:171], v225, s[48:51], s61 offen offset:2048 sc1
buffer_store_dwordx4 v[172:175], v225, s[48:51], s61 offen offset:3072 sc1
L_kvxd_2:
s_lshl_b32 s61, s6, 18
s_lshl_b32 s59, s5, 10
s_add_u32 s61, s61, s59
s_add_u32 s61, s61, 262144
s_cmp_eq_u32 s4, 0
s_cselect_b32 s77, 0, 1
v_min_u32 v243, 15, v1
v_lshlrev_b32 v243, 14, v243
v_add_u32 v243, 4, v243
s_mul_i32 s59, s6, 56
s_lshl_b32 s60, s4, 3
s_add_u32 s59, s59, s60
s_mul_i32 s72, s59, 896
s_lshl_b32 s75, s6, 7
s_lshl_b32 s73, s4, 10
v_and_b32 v232, 7, v1
v_bfe_u32 v233, v1, 4, 1
v_lshlrev_b32 v233, 2, v233
v_xor_b32 v232, v232, v233
v_lshlrev_b32 v232, 4, v232
v_lshrrev_b32 v233, 3, v1
v_mul_u32_u24 v233, 896, v233
v_add_u32 v10, v232, v233
ds_read_b128 v[24:27], v2 offset:0
ds_read_b64_tr_b16 v[32:33], v6 offset:14336
ds_read_b64_tr_b16 v[34:35], v6 offset:14448
ds_read_b128 v[28:31], v2 offset:4096
ds_read_b128 v[36:39], v3 offset:0
ds_read_b64_tr_b16 v[44:45], v6 offset:16128
ds_read_b64_tr_b16 v[46:47], v6 offset:16240
ds_read_b128 v[40:43], v3 offset:4096
s_waitcnt lgkmcnt(0)
v_mfma_f32_32x32x16_bf16 v[128:143], v[32:35], v[24:27], 0
ds_read_b128 v[64:67], v4 offset:0
ds_read_b64_tr_b16 v[72:73], v6 offset:17920
ds_read_b64_tr_b16 v[74:75], v6 offset:18032
ds_read_b128 v[68:71], v4 offset:4096
ds_read_b128 v[76:79], v5 offset:0
ds_read_b64_tr_b16 v[84:85], v6 offset:19712
ds_read_b64_tr_b16 v[86:87], v6 offset:19824
ds_read_b128 v[80:83], v5 offset:4096
v_mfma_f32_32x32x16_bf16 v[144:159], v[32:35], v[28:31], 0
v_mfma_f32_32x32x16_bf16 v[128:143], v[44:47], v[36:39], v[128:143]
v_mfma_f32_32x32x16_bf16 v[144:159], v[44:47], v[40:43], v[144:159]
s_waitcnt lgkmcnt(0)
v_mfma_f32_32x32x16_bf16 v[128:143], v[72:75], v[64:67], v[128:143]
ds_read_b128 v[24:27], v2 offset:16384
ds_read_b64_tr_b16 v[32:33], v6 offset:21504
ds_read_b64_tr_b16 v[34:35], v6 offset:21616
ds_read_b128 v[28:31], v2 offset:20480
ds_read_b128 v[36:39], v3 offset:16384
ds_read_b64_tr_b16 v[44:45], v6 offset:23296
ds_read_b64_tr_b16 v[46:47], v6 offset:23408
ds_read_b128 v[40:43], v3 offset:20480
v_mfma_f32_32x32x16_bf16 v[144:159], v[72:75], v[68:71], v[144:159]
v_mfma_f32_32x32x16_bf16 v[128:143], v[84:87], v[76:79], v[128:143]
v_mfma_f32_32x32x16_bf16 v[144:159], v[84:87], v[80:83], v[144:159]
s_waitcnt lgkmcnt(0)
v_mfma_f32_32x32x16_bf16 v[128:143], v[32:35], v[24:27], v[128:143]
ds_read_b128 v[64:67], v4 offset:16384
ds_read_b64_tr_b16 v[72:73], v6 offset:25088
ds_read_b64_tr_b16 v[74:75], v6 offset:25200
ds_read_b128 v[68:71], v4 offset:20480
ds_read_b128 v[76:79], v5 offset:16384
ds_read_b64_tr_b16 v[84:85], v6 offset:26880
ds_read_b64_tr_b16 v[86:87], v6 offset:26992
ds_read_b128 v[80:83], v5 offset:20480
v_mfma_f32_32x32x16_bf16 v[144:159], v[32:35], v[28:31], v[144:159]
v_mfma_f32_32x32x16_bf16 v[128:143], v[44:47], v[36:39], v[128:143]
v_mfma_f32_32x32x16_bf16 v[144:159], v[44:47], v[40:43], v[144:159]
s_waitcnt lgkmcnt(0)
v_mfma_f32_32x32x16_bf16 v[128:143], v[72:75], v[64:67], v[128:143]
ds_read_b128 v[24:27], v2 offset:32768
ds_read_b64_tr_b16 v[32:33], v6 offset:28672
ds_read_b64_tr_b16 v[34:35], v6 offset:28784
ds_read_b128 v[28:31], v2 offset:36864
ds_read_b128 v[36:39], v3 offset:32768
ds_read_b64_tr_b16 v[44:45], v6 offset:30464
ds_read_b64_tr_b16 v[46:47], v6 offset:30576
ds_read_b128 v[40:43], v3 offset:36864
v_mfma_f32_32x32x16_bf16 v[144:159], v[72:75], v[68:71], v[144:159]
v_mfma_f32_32x32x16_bf16 v[128:143], v[84:87], v[76:79], v[128:143]
v_mfma_f32_32x32x16_bf16 v[144:159], v[84:87], v[80:83], v[144:159]
s_waitcnt lgkmcnt(0)
s_barrier
v_mfma_f32_32x32x16_bf16 v[128:143], v[32:35], v[24:27], v[128:143]
ds_read_b128 v[64:67], v4 offset:32768
ds_read_b64_tr_b16 v[72:73], v6 offset:32256
ds_read_b64_tr_b16 v[74:75], v6 offset:32368
ds_read_b128 v[68:71], v4 offset:36864
ds_read_b128 v[76:79], v5 offset:32768
ds_read_b64_tr_b16 v[84:85], v6 offset:34048
ds_read_b64_tr_b16 v[86:87], v6 offset:34160
ds_read_b128 v[80:83], v5 offset:36864
v_mfma_f32_32x32x16_bf16 v[144:159], v[32:35], v[28:31], v[144:159]
s_add_u32 m0, s66, 129024
s_mul_i32 s67, s53, 172032
s_add_u32 s67, s67, s55
s_mov_b32 exec_hi, 0x00ffffff
buffer_load_dwordx4 v14, s[44:47], s67 offen lds
s_mov_b32 exec_hi, -1
v_mfma_f32_32x32x16_bf16 v[128:143], v[44:47], v[36:39], v[128:143]
v_mfma_f32_32x32x16_bf16 v[144:159], v[44:47], v[40:43], v[144:159]
s_mov_b32 exec_hi, 0x00ffffff
buffer_load_dwordx4 v15, s[44:47], s67 offen offset:896 lds
s_mov_b32 exec_hi, -1
s_add_u32 s53, s53, 1
s_cmp_ge_u32 s53, 7
s_cselect_b32 s60, 7, 0
s_sub_u32 s53, s53, s60
s_waitcnt lgkmcnt(0)
v_mfma_f32_32x32x16_bf16 v[128:143], v[72:75], v[64:67], v[128:143]
ds_read_b128 v[24:27], v2 offset:49152
ds_read_b64_tr_b16 v[32:33], v6 offset:0
ds_read_b64_tr_b16 v[34:35], v6 offset:112
ds_read_b128 v[28:31], v2 offset:53248
ds_read_b128 v[36:39], v3 offset:49152
ds_read_b64_tr_b16 v[44:45], v6 offset:1792
ds_read_b64_tr_b16 v[46:47], v6 offset:1904
ds_read_b128 v[40:43], v3 offset:53248
v_mfma_f32_32x32x16_bf16 v[144:159], v[72:75], v[68:71], v[144:159]
s_add_u32 m0, s66, 136192
s_mul_i32 s67, s53, 172032
s_add_u32 s67, s67, s55
s_mov_b32 exec_hi, 0x00ffffff
buffer_load_dwordx4 v14, s[44:47], s67 offen lds
s_mov_b32 exec_hi, -1
v_mfma_f32_32x32x16_bf16 v[128:143], v[84:87], v[76:79], v[128:143]
v_mfma_f32_32x32x16_bf16 v[144:159], v[84:87], v[80:83], v[144:159]
s_mov_b32 exec_hi, 0x00ffffff
buffer_load_dwordx4 v15, s[44:47], s67 offen offset:896 lds
s_mov_b32 exec_hi, -1
s_add_u32 s53, s53, 1
s_cmp_ge_u32 s53, 7
s_cselect_b32 s60, 7, 0
s_sub_u32 s53, s53, s60
s_waitcnt lgkmcnt(0)
s_cmp_eq_u32 s4, 0
s_cbranch_scc0 L_h1i_3
s_mov_b32 s59, s61
buffer_load_dwordx4 v[160:163], v225, s[48:51], s59 offen sc1
s_add_u32 s59, s59, 16384
buffer_load_dwordx4 v[164:167], v225, s[48:51], s59 offen sc1
s_add_u32 s59, s59, 16384
buffer_load_dwordx4 v[168:171], v225, s[48:51], s59 offen sc1
s_add_u32 s59, s59, 16384
buffer_load_dwordx4 v[172:175], v225, s[48:51], s59 offen sc1
s_add_u32 s59, s59, 16384
buffer_load_dwordx4 v[176:179], v225, s[48:51], s59 offen sc1
s_add_u32 s59, s59, 16384
buffer_load_dwordx4 v[180:183], v225, s[48:51], s59 offen sc1
s_add_u32 s59, s59, 16384
buffer_load_dwordx4 v[184:187], v225, s[48:51], s59 offen sc1
s_add_u32 s59, s59, 16384
buffer_load_dwordx4 v[188:191], v225, s[48:51], s59 offen sc1
s_add_u32 s59, s59, 16384
buffer_load_dwordx4 v[192:195], v225, s[48:51], s59 offen sc1
s_add_u32 s59, s59, 16384
buffer_load_dwordx4 v[196:199], v225, s[48:51], s59 offen sc1
s_add_u32 s59, s59, 16384
buffer_load_dwordx4 v[200:203], v225, s[48:51], s59 offen sc1
s_add_u32 s59, s59, 16384
buffer_load_dwordx4 v[204:207], v225, s[48:51], s59 offen sc1
s_add_u32 s59, s59, 16384
buffer_load_dwordx4 v[208:211], v225, s[48:51], s59 offen sc1
s_add_u32 s59, s59, 16384
buffer_load_dwordx4 v[212:215], v225, s[48:51], s59 offen sc1
s_add_u32 s59, s59, 16384
buffer_load_dwordx4 v[216:219], v225, s[48:51], s59 offen sc1
s_add_u32 s59, s59, 16384
buffer_load_dwordx4 v[220:223], v225, s[48:51], s59 offen sc1
L_h1i_3:
v_mfma_f32_32x32x16_bf16 v[128:143], v[32:35], v[24:27], v[128:143]
ds_read_b128 v[64:67], v4 offset:49152
ds_read_b64_tr_b16 v[72:73], v6 offset:3584
ds_read_b64_tr_b16 v[74:75], v6 offset:3696
ds_read_b128 v[68:71], v4 offset:53248
ds_read_b128 v[76:79], v5 offset:49152
ds_read_b64_tr_b16 v[84:85], v6 offset:5376
ds_read_b64_tr_b16 v[86:87], v6 offset:5488
ds_read_b128 v[80:83], v5 offset:53248
v_mfma_f32_32x32x16_bf16 v[144:159], v[32:35], v[28:31], v[144:159]
v_mfma_f32_32x32x16_bf16 v[128:143], v[44:47], v[36:39], v[128:143]
v_mfma_f32_32x32x16_bf16 v[144:159], v[44:47], v[40:43], v[144:159]
s_waitcnt lgkmcnt(0)
v_mfma_f32_32x32x16_bf16 v[128:143], v[72:75], v[64:67], v[128:143]
ds_read_b128 v[24:27], v16 offset:0
ds_read_b64_tr_b16 v[32:33], v6 offset:7168
ds_read_b64_tr_b16 v[34:35], v6 offset:7280
ds_read_b128 v[28:31], v16 offset:4096
ds_read_b128 v[36:39], v17 offset:0
ds_read_b64_tr_b16 v[44:45], v6 offset:8960
ds_read_b64_tr_b16 v[46:47], v6 offset:9072
ds_read_b128 v[40:43], v17 offset:4096
v_mfma_f32_32x32x16_bf16 v[144:159], v[72:75], v[68:71], v[144:159]
v_mfma_f32_32x32x16_bf16 v[128:143], v[84:87], v[76:79], v[128:143]
v_mfma_f32_32x32x16_bf16 v[144:159], v[84:87], v[80:83], v[144:159]
s_waitcnt lgkmcnt(0)
v_mfma_f32_32x32x16_bf16 v[128:143], v[32:35], v[24:27], v[128:143]
ds_read_b128 v[64:67], v18 offset:0
ds_read_b64_tr_b16 v[72:73], v6 offset:10752
ds_read_b64_tr_b16 v[74:75], v6 offset:10864
ds_read_b128 v[68:71], v18 offset:4096
ds_read_b128 v[76:79], v19 offset:0
ds_read_b64_tr_b16 v[84:85], v6 offset:12544
ds_read_b64_tr_b16 v[86:87], v6 offset:12656
ds_read_b128 v[80:83], v19 offset:4096
v_mfma_f32_32x32x16_bf16 v[144:159], v[32:35], v[28:31], v[144:159]
v_mfma_f32_32x32x16_bf16 v[128:143], v[44:47], v[36:39], v[128:143]
v_mfma_f32_32x32x16_bf16 v[144:159], v[44:47], v[40:43], v[144:159]
s_waitcnt lgkmcnt(0)
s_cmp_eq_u32 s4, 0
s_cbranch_scc0 L_w9_4
s_waitcnt vmcnt(16)
s_branch L_w9d_5
L_w9_4:
s_waitcnt vmcnt(0)
L_w9d_5:
s_barrier
v_mfma_f32_32x32x16_bf16 v[128:143], v[72:75], v[64:67], v[128:143]
ds_read_b128 v[24:27], v16 offset:16384
ds_read_b64_tr_b16 v[32:33], v6 offset:14336
ds_read_b64_tr_b16 v[34:35], v6 offset:14448
ds_read_b128 v[28:31], v16 offset:20480
ds_read_b128 v[36:39], v17 offset:16384
ds_read_b64_tr_b16 v[44:45], v6 offset:16128
ds_read_b64_tr_b16 v[46:47], v6 offset:16240
ds_read_b128 v[40:43], v17 offset:20480
v_mfma_f32_32x32x16_bf16 v[144:159], v[72:75], v[68:71], v[144:159]
v_mfma_f32_32x32x16_bf16 v[128:143], v[84:87], v[76:79], v[128:143]
v_mfma_f32_32x32x16_bf16 v[144:159], v[84:87], v[80:83], v[144:159]
s_waitcnt lgkmcnt(0)
s_cmp_eq_u32 s77, 0
s_cbranch_scc0 L_cp_6
s_waitcnt vmcnt(0)
v_mov_b32 v236, s52
v_mov_b32 v237, s52
v_min3_u32 v236, v236, v161, v163
v_max3_u32 v237, v237, v161, v163
v_min3_u32 v236, v236, v165, v167
v_max3_u32 v237, v237, v165, v167
v_min3_u32 v236, v236, v169, v171
v_max3_u32 v237, v237, v169, v171
v_min3_u32 v236, v236, v173, v175
v_max3_u32 v237, v237, v173, v175
v_min3_u32 v236, v236, v177, v179
v_max3_u32 v237, v237, v177, v179
v_min3_u32 v236, v236, v181, v183
v_max3_u32 v237, v237, v181, v183
v_min3_u32 v236, v236, v185, v187
v_max3_u32 v237, v237, v185, v187
v_min3_u32 v236, v236, v189, v191
v_max3_u32 v237, v237, v189, v191
v_min3_u32 v236, v236, v193, v195
v_max3_u32 v237, v237, v193, v195
v_min3_u32 v236, v236, v197, v199
v_max3_u32 v237, v237, v197, v199
v_min3_u32 v236, v236, v201, v203
v_max3_u32 v237, v237, v201, v203
v_min3_u32 v236, v236, v205, v207
v_max3_u32 v237, v237, v205, v207
v_min3_u32 v236, v236, v209, v211
v_max3_u32 v237, v237, v209, v211
v_min3_u32 v236, v236, v213, v215
v_max3_u32 v237, v237, v213, v215
v_min3_u32 v236, v236, v217, v219
v_max3_u32 v237, v237, v217, v219
v_min3_u32 v236, v236, v221, v223
v_max3_u32 v237, v237, v221, v223
v_cmp_ne_u32 vcc, v236, v237
s_nop 4
s_cbranch_vccnz L_cpr_7
v_add_f32 v160, v160, v164
v_add_f32 v162, v162, v166
v_add_f32 v168, v168, v172
v_add_f32 v170, v170, v174
v_add_f32 v176, v176, v180
v_add_f32 v178, v178, v182
v_add_f32 v184, v184, v188
v_add_f32 v186, v186, v190
v_add_f32 v192, v192, v196
v_add_f32 v194, v194, v198
v_add_f32 v200, v200, v204
v_add_f32 v202, v202, v206
v_add_f32 v208, v208, v212
v_add_f32 v210, v210, v214
v_add_f32 v216, v216, v220
v_add_f32 v218, v218, v222
v_add_f32 v160, v160, v168
v_add_f32 v162, v162, v170
v_add_f32 v176, v176, v184
v_add_f32 v178, v178, v186
v_add_f32 v192, v192, v200
v_add_f32 v194, v194, v202
v_add_f32 v208, v208, v216
v_add_f32 v210, v210, v218
v_add_f32 v160, v160, v176
v_add_f32 v162, v162, v178
v_add_f32 v192, v192, v208
v_add_f32 v194, v194, v210
v_add_f32 v160, v160, v192
v_add_f32 v162, v162, v194
v_cvt_pk_bf16_f32 v238, v160, v162
v_mov_b32 v239, s52
v_lshlrev_b32 v242, 3, v1
s_lshl_b32 s59, s6, 13
s_lshl_b32 s60, s5, 9
s_add_u32 s59, s59, s60
s_add_u32 s59, s59, 131072
buffer_store_dwordx2 v[238:239], v242, s[48:51], s59 offen sc1
s_mov_b32 s77, 1
s_branch L_cp_6
L_cpr_7:
s_mov_b32 s59, s61
buffer_load_dwordx4 v[160:163], v225, s[48:51], s59 offen sc1
s_add_u32 s59, s59, 16384
buffer_load_dwordx4 v[164:167], v225, s[48:51], s59 offen sc1
s_add_u32 s59, s59, 16384
buffer_load_dwordx4 v[168:171], v225, s[48:51], s59 offen sc1
s_add_u32 s59, s59, 16384
buffer_load_dwordx4 v[172:175], v225, s[48:51], s59 offen sc1
s_add_u32 s59, s59, 16384
buffer_load_dwordx4 v[176:179], v225, s[48:51], s59 offen sc1
s_add_u32 s59, s59, 16384
buffer_load_dwordx4 v[180:183], v225, s[48:51], s59 offen sc1
s_add_u32 s59, s59, 16384
buffer_load_dwordx4 v[184:187], v225, s[48:51], s59 offen sc1
s_add_u32 s59, s59, 16384
buffer_load_dwordx4 v[188:191], v225, s[48:51], s59 offen sc1
s_add_u32 s59, s59, 16384
buffer_load_dwordx4 v[192:195], v225, s[48:51], s59 offen sc1
s_add_u32 s59, s59, 16384
buffer_load_dwordx4 v[196:199], v225, s[48:51], s59 offen sc1
s_add_u32 s59, s59, 16384
buffer_load_dwordx4 v[200:203], v225, s[48:51], s59 offen sc1
s_add_u32 s59, s59, 16384
buffer_load_dwordx4 v[204:207], v225, s[48:51], s59 offen sc1
s_add_u32 s59, s59, 16384
buffer_load_dwordx4 v[208:211], v225, s[48:51], s59 offen sc1
s_add_u32 s59, s59, 16384
buffer_load_dwordx4 v[212:215], v225, s[48:51], s59 offen sc1
s_add_u32 s59, s59, 16384
buffer_load_dwordx4 v[216:219], v225, s[48:51], s59 offen sc1
s_add_u32 s59, s59, 16384
buffer_load_dwordx4 v[220:223], v225, s[48:51], s59 offen sc1
L_cp_6:
v_mfma_f32_32x32x16_bf16 v[128:143], v[32:35], v[24:27], v[128:143]
ds_read_b128 v[64:67], v18 offset:16384
ds_read_b64_tr_b16 v[72:73], v6 offset:17920
ds_read_b64_tr_b16 v[74:75], v6 offset:18032
ds_read_b128 v[68:71], v18 offset:20480
ds_read_b128 v[76:79], v19 offset:16384
ds_read_b64_tr_b16 v[84:85], v6 offset:19712
ds_read_b64_tr_b16 v[86:87], v6 offset:19824
ds_read_b128 v[80:83], v19 offset:20480
v_mfma_f32_32x32x16_bf16 v[144:159], v[32:35], v[28:31], v[144:159]
v_mfma_f32_32x32x16_bf16 v[128:143], v[44:47], v[36:39], v[128:143]
v_mfma_f32_32x32x16_bf16 v[144:159], v[44:47], v[40:43], v[144:159]
s_waitcnt lgkmcnt(0)
v_mfma_f32_32x32x16_bf16 v[128:143], v[72:75], v[64:67], v[128:143]
ds_read_b128 v[24:27], v16 offset:32768
ds_read_b64_tr_b16 v[32:33], v6 offset:21504
ds_read_b64_tr_b16 v[34:35], v6 offset:21616
ds_read_b128 v[28:31], v16 offset:36864
ds_read_b128 v[36:39], v17 offset:32768
ds_read_b64_tr_b16 v[44:45], v6 offset:23296
ds_read_b64_tr_b16 v[46:47], v6 offset:23408
ds_read_b128 v[40:43], v17 offset:36864
v_mfma_f32_32x32x16_bf16 v[144:159], v[72:75], v[68:71], v[144:159]
v_mfma_f32_32x32x16_bf16 v[128:143], v[84:87], v[76:79], v[128:143]
v_mfma_f32_32x32x16_bf16 v[144:159], v[84:87], v[80:83], v[144:159]
s_waitcnt lgkmcnt(0)
v_mfma_f32_32x32x16_bf16 v[128:143], v[32:35], v[24:27], v[128:143]
ds_read_b128 v[64:67], v18 offset:32768
ds_read_b64_tr_b16 v[72:73], v6 offset:25088
ds_read_b64_tr_b16 v[74:75], v6 offset:25200
ds_read_b128 v[68:71], v18 offset:36864
ds_read_b128 v[76:79], v19 offset:32768
ds_read_b64_tr_b16 v[84:85], v6 offset:26880
ds_read_b64_tr_b16 v[86:87], v6 offset:26992
ds_read_b128 v[80:83], v19 offset:36864
v_mfma_f32_32x32x16_bf16 v[144:159], v[32:35], v[28:31], v[144:159]
v_mfma_f32_32x32x16_bf16 v[128:143], v[44:47], v[36:39], v[128:143]
v_mfma_f32_32x32x16_bf16 v[144:159], v[44:47], v[40:43], v[144:159]
s_waitcnt lgkmcnt(0)
s_cmp_eq_u32 s77, 0
s_cbranch_scc0 L_cp_8
s_waitcnt vmcnt(0)
v_mov_b32 v236, s52
v_mov_b32 v237, s52
v_min3_u32 v236, v236, v161, v163
v_max3_u32 v237, v237, v161, v163
v_min3_u32 v236, v236, v165, v167
v_max3_u32 v237, v237, v165, v167
v_min3_u32 v236, v236, v169, v171
v_max3_u32 v237, v237, v169, v171
v_min3_u32 v236, v236, v173, v175
v_max3_u32 v237, v237, v173, v175
v_min3_u32 v236, v236, v177, v179
v_max3_u32 v237, v237, v177, v179
v_min3_u32 v236, v236, v181, v183
v_max3_u32 v237, v237, v181, v183
v_min3_u32 v236, v236, v185, v187
v_max3_u32 v237, v237, v185, v187
v_min3_u32 v236, v236, v189, v191
v_max3_u32 v237, v237, v189, v191
v_min3_u32 v236, v236, v193, v195
v_max3_u32 v237, v237, v193, v195
v_min3_u32 v236, v236, v197, v199
v_max3_u32 v237, v237, v197, v199
v_min3_u32 v236, v236, v201, v203
v_max3_u32 v237, v237, v201, v203
v_min3_u32 v236, v236, v205, v207
v_max3_u32 v237, v237, v205, v207
v_min3_u32 v236, v236, v209, v211
v_max3_u32 v237, v237, v209, v211
v_min3_u32 v236, v236, v213, v215
v_max3_u32 v237, v237, v213, v215
v_min3_u32 v236, v236, v217, v219
v_max3_u32 v237, v237, v217, v219
v_min3_u32 v236, v236, v221, v223
v_max3_u32 v237, v237, v221, v223
v_cmp_ne_u32 vcc, v236, v237
s_nop 4
s_cbranch_vccnz L_cp_8
v_add_f32 v160, v160, v164
v_add_f32 v162, v162, v166
v_add_f32 v168, v168, v172
v_add_f32 v170, v170, v174
v_add_f32 v176, v176, v180
v_add_f32 v178, v178, v182
v_add_f32 v184, v184, v188
v_add_f32 v186, v186, v190
v_add_f32 v192, v192, v196
v_add_f32 v194, v194, v198
v_add_f32 v200, v200, v204
v_add_f32 v202, v202, v206
v_add_f32 v208, v208, v212
v_add_f32 v210, v210, v214
v_add_f32 v216, v216, v220
v_add_f32 v218, v218, v222
v_add_f32 v160, v160, v168
v_add_f32 v162, v162, v170
v_add_f32 v176, v176, v184
v_add_f32 v178, v178, v186
v_add_f32 v192, v192, v200
v_add_f32 v194, v194, v202
v_add_f32 v208, v208, v216
v_add_f32 v210, v210, v218
v_add_f32 v160, v160, v176
v_add_f32 v162, v162, v178
v_add_f32 v192, v192, v208
v_add_f32 v194, v194, v210
v_add_f32 v160, v160, v192
v_add_f32 v162, v162, v194
v_cvt_pk_bf16_f32 v238, v160, v162
v_mov_b32 v239, s52
v_lshlrev_b32 v242, 3, v1
s_lshl_b32 s59, s6, 13
s_lshl_b32 s60, s5, 9
s_add_u32 s59, s59, s60
s_add_u32 s59, s59, 131072
buffer_store_dwordx2 v[238:239], v242, s[48:51], s59 offen sc1
s_mov_b32 s77, 1
L_cp_8:
v_mfma_f32_32x32x16_bf16 v[128:143], v[72:75], v[64:67], v[128:143]
v_mfma_f32_32x32x16_bf16 v[144:159], v[72:75], v[68:71], v[144:159]
v_mfma_f32_32x32x16_bf16 v[128:143], v[84:87], v[76:79], v[128:143]
v_mfma_f32_32x32x16_bf16 v[144:159], v[84:87], v[80:83], v[144:159]
s_barrier
s_nop 7
s_nop 3
s_cmp_eq_u32 s77, 0
s_cbranch_scc0 L_nored_10
s_mov_b32 s63, 0
L_p1_11:
L_cp_14:
buffer_load_dword v241, v243, s[48:51], s61 offen sc1
s_add_u32 s63, s63, 1
s_waitcnt vmcnt(0)
v_cmp_ne_u32 vcc, s52, v241
s_cmp_lt_u32 s63, 1048576
s_cbranch_scc0 L_cpd_15
s_cbranch_vccnz L_cp_14
L_cpd_15:
s_mov_b32 s59, s61
buffer_load_dwordx4 v[160:163], v225, s[48:51], s59 offen sc1
s_add_u32 s59, s59, 16384
buffer_load_dwordx4 v[164:167], v225, s[48:51], s59 offen sc1
s_add_u32 s59, s59, 16384
buffer_load_dwordx4 v[168:171], v225, s[48:51], s59 offen sc1
s_add_u32 s59, s59, 16384
buffer_load_dwordx4 v[172:175], v225, s[48:51], s59 offen sc1
s_add_u32 s59, s59, 16384
buffer_load_dwordx4 v[176:179], v225, s[48:51], s59 offen sc1
s_add_u32 s59, s59, 16384
buffer_load_dwordx4 v[180:183], v225, s[48:51], s59 offen sc1
s_add_u32 s59, s59, 16384
buffer_load_dwordx4 v[184:187], v225, s[48:51], s59 offen sc1
s_add_u32 s59, s59, 16384
buffer_load_dwordx4 v[188:191], v225, s[48:51], s59 offen sc1
s_add_u32 s59, s59, 16384
buffer_load_dwordx4 v[192:195], v225, s[48:51], s59 offen sc1
s_add_u32 s59, s59, 16384
buffer_load_dwordx4 v[196:199], v225, s[48:51], s59 offen sc1
s_add_u32 s59, s59, 16384
buffer_load_dwordx4 v[200:203], v225, s[48:51], s59 offen sc1
s_add_u32 s59, s59, 16384
buffer_load_dwordx4 v[204:207], v225, s[48:51], s59 offen sc1
s_add_u32 s59, s59, 16384
buffer_load_dwordx4 v[208:211], v225, s[48:51], s59 offen sc1
s_add_u32 s59, s59, 16384
buffer_load_dwordx4 v[212:215], v225, s[48:51], s59 offen sc1
s_add_u32 s59, s59, 16384
buffer_load_dwordx4 v[216:219], v225, s[48:51], s59 offen sc1
s_add_u32 s59, s59, 16384
buffer_load_dwordx4 v[220:223], v225, s[48:51], s59 offen sc1
L_p1c_13:
s_waitcnt vmcnt(0)
v_mov_b32 v236, s52
v_mov_b32 v237, s52
v_min3_u32 v236, v236, v161, v163
v_max3_u32 v237, v237, v161, v163
v_min3_u32 v236, v236, v165, v167
v_max3_u32 v237, v237, v165, v167
v_min3_u32 v236, v236, v169, v171
v_max3_u32 v237, v237, v169, v171
v_min3_u32 v236, v236, v173, v175
v_max3_u32 v237, v237, v173, v175
v_min3_u32 v236, v236, v177, v179
v_max3_u32 v237, v237, v177, v179
v_min3_u32 v236, v236, v181, v183
v_max3_u32 v237, v237, v181, v183
v_min3_u32 v236, v236, v185, v187
v_max3_u32 v237, v237, v185, v187
v_min3_u32 v236, v236, v189, v191
v_max3_u32 v237, v237, v189, v191
v_min3_u32 v236, v236, v193, v195
v_max3_u32 v237, v237, v193, v195
v_min3_u32 v236, v236, v197, v199
v_max3_u32 v237, v237, v197, v199
v_min3_u32 v236, v236, v201, v203
v_max3_u32 v237, v237, v201, v203
v_min3_u32 v236, v236, v205, v207
v_max3_u32 v237, v237, v205, v207
v_min3_u32 v236, v236, v209, v211
v_max3_u32 v237, v237, v209, v211
v_min3_u32 v236, v236, v213, v215
v_max3_u32 v237, v237, v213, v215
v_min3_u32 v236, v236, v217, v219
v_max3_u32 v237, v237, v217, v219
v_min3_u32 v236, v236, v221, v223
v_max3_u32 v237, v237, v221, v223
v_cmp_ne_u32 vcc, v236, v237
s_add_u32 s63, s63, 1
s_cmp_lt_u32 s63, 1048576
s_cbranch_scc0 L_p1d_12
s_cbranch_vccnz L_p1_11
L_p1d_12:
v_add_f32 v160, v160, v164
v_add_f32 v162, v162, v166
v_add_f32 v168, v168, v172
v_add_f32 v170, v170, v174
v_add_f32 v176, v176, v180
v_add_f32 v178, v178, v182
v_add_f32 v184, v184, v188
v_add_f32 v186, v186, v190
v_add_f32 v192, v192, v196
v_add_f32 v194, v194, v198
v_add_f32 v200, v200, v204
v_add_f32 v202, v202, v206
v_add_f32 v208, v208, v212
v_add_f32 v210, v210, v214
v_add_f32 v216, v216, v220
v_add_f32 v218, v218, v222
v_add_f32 v160, v160, v168
v_add_f32 v162, v162, v170
v_add_f32 v176, v176, v184
v_add_f32 v178, v178, v186
v_add_f32 v192, v192, v200
v_add_f32 v194, v194, v202
v_add_f32 v208, v208, v216
v_add_f32 v210, v210, v218
v_add_f32 v160, v160, v176
v_add_f32 v162, v162, v178
v_add_f32 v192, v192, v208
v_add_f32 v194, v194, v210
v_add_f32 v160, v160, v192
v_add_f32 v162, v162, v194
v_cvt_pk_bf16_f32 v238, v160, v162
v_mov_b32 v239, s52
v_lshlrev_b32 v242, 3, v1
s_lshl_b32 s59, s6, 13
s_lshl_b32 s60, s5, 9
s_add_u32 s59, s59, s60
s_add_u32 s59, s59, 131072
buffer_store_dwordx2 v[238:239], v242, s[48:51], s59 offen sc1
s_mov_b32 s77, 1
L_nored_10:
v_lshlrev_b32 v242, 3, v1
s_lshl_b32 s61, s6, 13
s_lshl_b32 s59, s58, 12
s_add_u32 s61, s61, s59
s_add_u32 s61, s61, 131072
v_pk_mul_f32 v[228:229], v[128:129], s[64:65] op_sel_hi:[1,0]
v_pk_mul_f32 v[230:231], v[130:131], s[64:65] op_sel_hi:[1,0]
v_exp_f32_e64 v228, v228 clamp
v_exp_f32_e64 v229, v229 clamp
v_exp_f32_e64 v230, v230 clamp
v_exp_f32_e64 v231, v231 clamp
v_max_f32 v128, 0, v128
v_max_f32 v129, 0, v129
v_max_f32 v130, 0, v130
v_max_f32 v131, 0, v131
v_pk_add_f32 v[228:229], v[228:229], s[64:65] op_sel:[0,1] op_sel_hi:[1,1]
v_pk_add_f32 v[230:231], v[230:231], s[64:65] op_sel:[0,1] op_sel_hi:[1,1]
v_pk_add_f32 v[128:129], v[128:129], v[228:229]
v_pk_add_f32 v[130:131], v[130:131], v[230:231]
v_pk_mul_f32 v[228:229], v[132:133], s[64:65] op_sel_hi:[1,0]
v_pk_mul_f32 v[230:231], v[134:135], s[64:65] op_sel_hi:[1,0]
v_exp_f32_e64 v228, v228 clamp
v_exp_f32_e64 v229, v229 clamp
v_exp_f32_e64 v230, v230 clamp
v_exp_f32_e64 v231, v231 clamp
v_max_f32 v132, 0, v132
v_max_f32 v133, 0, v133
v_max_f32 v134, 0, v134
v_max_f32 v135, 0, v135
v_pk_add_f32 v[228:229], v[228:229], s[64:65] op_sel:[0,1] op_sel_hi:[1,1]
v_pk_add_f32 v[230:231], v[230:231], s[64:65] op_sel:[0,1] op_sel_hi:[1,1]
v_pk_add_f32 v[132:133], v[132:133], v[228:229]
v_pk_add_f32 v[134:135], v[134:135], v[230:231]
v_pk_mul_f32 v[228:229], v[136:137], s[64:65] op_sel_hi:[1,0]
v_pk_mul_f32 v[230:231], v[138:139], s[64:65] op_sel_hi:[1,0]
v_exp_f32_e64 v228, v228 clamp
v_exp_f32_e64 v229, v229 clamp
v_exp_f32_e64 v230, v230 clamp
v_exp_f32_e64 v231, v231 clamp
v_max_f32 v136, 0, v136
v_max_f32 v137, 0, v137
v_max_f32 v138, 0, v138
v_max_f32 v139, 0, v139
v_pk_add_f32 v[228:229], v[228:229], s[64:65] op_sel:[0,1] op_sel_hi:[1,1]
v_pk_add_f32 v[230:231], v[230:231], s[64:65] op_sel:[0,1] op_sel_hi:[1,1]
v_pk_add_f32 v[136:137], v[136:137], v[228:229]
v_pk_add_f32 v[138:139], v[138:139], v[230:231]
v_pk_mul_f32 v[228:229], v[140:141], s[64:65] op_sel_hi:[1,0]
v_pk_mul_f32 v[230:231], v[142:143], s[64:65] op_sel_hi:[1,0]
v_exp_f32_e64 v228, v228 clamp
v_exp_f32_e64 v229, v229 clamp
v_exp_f32_e64 v230, v230 clamp
v_exp_f32_e64 v231, v231 clamp
v_max_f32 v140, 0, v140
v_max_f32 v141, 0, v141
v_max_f32 v142, 0, v142
v_max_f32 v143, 0, v143
v_pk_add_f32 v[228:229], v[228:229], s[64:65] op_sel:[0,1] op_sel_hi:[1,1]
v_pk_add_f32 v[230:231], v[230:231], s[64:65] op_sel:[0,1] op_sel_hi:[1,1]
v_pk_add_f32 v[140:141], v[140:141], v[228:229]
v_pk_add_f32 v[142:143], v[142:143], v[230:231]
v_pk_mul_f32 v[228:229], v[144:145], s[64:65] op_sel_hi:[1,0]
v_pk_mul_f32 v[230:231], v[146:147], s[64:65] op_sel_hi:[1,0]
v_exp_f32_e64 v228, v228 clamp
v_exp_f32_e64 v229, v229 clamp
v_exp_f32_e64 v230, v230 clamp
v_exp_f32_e64 v231, v231 clamp
v_max_f32 v144, 0, v144
v_max_f32 v145, 0, v145
v_max_f32 v146, 0, v146
v_max_f32 v147, 0, v147
v_pk_add_f32 v[228:229], v[228:229], s[64:65] op_sel:[0,1] op_sel_hi:[1,1]
v_pk_add_f32 v[230:231], v[230:231], s[64:65] op_sel:[0,1] op_sel_hi:[1,1]
v_pk_add_f32 v[144:145], v[144:145], v[228:229]
v_pk_add_f32 v[146:147], v[146:147], v[230:231]
v_pk_mul_f32 v[228:229], v[148:149], s[64:65] op_sel_hi:[1,0]
v_pk_mul_f32 v[230:231], v[150:151], s[64:65] op_sel_hi:[1,0]
v_exp_f32_e64 v228, v228 clamp
v_exp_f32_e64 v229, v229 clamp
v_exp_f32_e64 v230, v230 clamp
v_exp_f32_e64 v231, v231 clamp
v_max_f32 v148, 0, v148
v_max_f32 v149, 0, v149
v_max_f32 v150, 0, v150
v_max_f32 v151, 0, v151
v_pk_add_f32 v[228:229], v[228:229], s[64:65] op_sel:[0,1] op_sel_hi:[1,1]
v_pk_add_f32 v[230:231], v[230:231], s[64:65] op_sel:[0,1] op_sel_hi:[1,1]
v_pk_add_f32 v[148:149], v[148:149], v[228:229]
v_pk_add_f32 v[150:151], v[150:151], v[230:231]
v_pk_mul_f32 v[228:229], v[152:153], s[64:65] op_sel_hi:[1,0]
v_pk_mul_f32 v[230:231], v[154:155], s[64:65] op_sel_hi:[1,0]
v_exp_f32_e64 v228, v228 clamp
v_exp_f32_e64 v229, v229 clamp
v_exp_f32_e64 v230, v230 clamp
v_exp_f32_e64 v231, v231 clamp
v_max_f32 v152, 0, v152
v_max_f32 v153, 0, v153
v_max_f32 v154, 0, v154
v_max_f32 v155, 0, v155
v_pk_add_f32 v[228:229], v[228:229], s[64:65] op_sel:[0,1] op_sel_hi:[1,1]
v_pk_add_f32 v[230:231], v[230:231], s[64:65] op_sel:[0,1] op_sel_hi:[1,1]
v_pk_add_f32 v[152:153], v[152:153], v[228:229]
v_pk_add_f32 v[154:155], v[154:155], v[230:231]
v_pk_mul_f32 v[228:229], v[156:157], s[64:65] op_sel_hi:[1,0]
v_pk_mul_f32 v[230:231], v[158:159], s[64:65] op_sel_hi:[1,0]
v_exp_f32_e64 v228, v228 clamp
v_exp_f32_e64 v229, v229 clamp
v_exp_f32_e64 v230, v230 clamp
v_exp_f32_e64 v231, v231 clamp
v_max_f32 v156, 0, v156
v_max_f32 v157, 0, v157
v_max_f32 v158, 0, v158
v_max_f32 v159, 0, v159
v_pk_add_f32 v[228:229], v[228:229], s[64:65] op_sel:[0,1] op_sel_hi:[1,1]
v_pk_add_f32 v[230:231], v[230:231], s[64:65] op_sel:[0,1] op_sel_hi:[1,1]
v_pk_add_f32 v[156:157], v[156:157], v[228:229]
v_pk_add_f32 v[158:159], v[158:159], v[230:231]
s_cmp_eq_u32 s6, 7
s_cbranch_scc1 L_wo_16
s_add_u32 m0, s73, 0
s_add_u32 s67, s72, s75
buffer_load_dwordx4 v10, s[36:39], s67 offen lds
s_add_u32 s72, s72, 28672
s_cmp_ge_u32 s72, 401408
s_cselect_b32 s60, 401408, 0
s_sub_u32 s72, s72, s60
s_add_u32 m0, s73, 4096
s_add_u32 s67, s72, s75
buffer_load_dwordx4 v10, s[36:39], s67 offen lds
s_add_u32 s72, s72, 28672
s_cmp_ge_u32 s72, 401408
s_cselect_b32 s60, 401408, 0
s_sub_u32 s72, s72, s60
s_add_u32 m0, s73, 8192
s_add_u32 s67, s72, s75
buffer_load_dwordx4 v10, s[36:39], s67 offen lds
s_add_u32 s72, s72, 28672
s_cmp_ge_u32 s72, 401408
s_cselect_b32 s60, 401408, 0
s_sub_u32 s72, s72, s60
s_add_u32 m0, s73, 12288
s_add_u32 s67, s72, s75
buffer_load_dwordx4 v10, s[36:39], s67 offen lds
s_add_u32 s72, s72, 28672
s_cmp_ge_u32 s72, 401408
s_cselect_b32 s60, 401408, 0
s_sub_u32 s72, s72, s60
s_add_u32 m0, s73, 16384
s_add_u32 s67, s72, s75
buffer_load_dwordx4 v10, s[36:39], s67 offen lds
s_add_u32 s72, s72, 28672
s_cmp_ge_u32 s72, 401408
s_cselect_b32 s60, 401408, 0
s_sub_u32 s72, s72, s60
s_add_u32 m0, s73, 20480
s_add_u32 s67, s72, s75
buffer_load_dwordx4 v10, s[36:39], s67 offen lds
s_add_u32 s72, s72, 28672
s_cmp_ge_u32 s72, 401408
s_cselect_b32 s60, 401408, 0
s_sub_u32 s72, s72, s60
L_wo_16:
buffer_load_dwordx2 v[160:161], v242, s[48:51], s61 offen offset:0 sc1
buffer_load_dwordx2 v[162:163], v242, s[48:51], s61 offen offset:512 sc1
buffer_load_dwordx2 v[164:165], v242, s[48:51], s61 offen offset:1024 sc1
buffer_load_dwordx2 v[166:167], v242, s[48:51], s61 offen offset:1536 sc1
buffer_load_dwordx2 v[168:169], v242, s[48:51], s61 offen offset:2048 sc1
buffer_load_dwordx2 v[170:171], v242, s[48:51], s61 offen offset:2560 sc1
buffer_load_dwordx2 v[172:173], v242, s[48:51], s61 offen offset:3072 sc1
buffer_load_dwordx2 v[174:175], v242, s[48:51], s61 offen offset:3584 sc1
s_cmp_eq_u32 s6, 7
s_cbranch_scc1 L_wo_17
s_add_u32 m0, s73, 24576
s_add_u32 s67, s72, s75
buffer_load_dwordx4 v10, s[36:39], s67 offen lds
s_add_u32 s72, s72, 28672
s_cmp_ge_u32 s72, 401408
s_cselect_b32 s60, 401408, 0
s_sub_u32 s72, s72, s60
s_add_u32 m0, s73, 28672
s_add_u32 s67, s72, s75
buffer_load_dwordx4 v10, s[36:39], s67 offen lds
s_add_u32 s72, s72, 28672
s_cmp_ge_u32 s72, 401408
s_cselect_b32 s60, 401408, 0
s_sub_u32 s72, s72, s60
s_add_u32 m0, s73, 32768
s_add_u32 s67, s72, s75
buffer_load_dwordx4 v10, s[36:39], s67 offen lds
s_add_u32 s72, s72, 28672
s_cmp_ge_u32 s72, 401408
s_cselect_b32 s60, 401408, 0
s_sub_u32 s72, s72, s60
s_add_u32 m0, s73, 36864
s_add_u32 s67, s72, s75
buffer_load_dwordx4 v10, s[36:39], s67 offen lds
s_add_u32 s72, s72, 28672
s_cmp_ge_u32 s72, 401408
s_cselect_b32 s60, 401408, 0
s_sub_u32 s72, s72, s60
s_add_u32 m0, s73, 40960
s_add_u32 s67, s72, s75
buffer_load_dwordx4 v10, s[36:39], s67 offen lds
s_add_u32 s72, s72, 28672
s_cmp_ge_u32 s72, 401408
s_cselect_b32 s60, 401408, 0
s_sub_u32 s72, s72, s60
s_add_u32 m0, s73, 45056
s_add_u32 s67, s72, s75
buffer_load_dwordx4 v10, s[36:39], s67 offen lds
s_add_u32 s72, s72, 28672
s_cmp_ge_u32 s72, 401408
s_cselect_b32 s60, 401408, 0
s_sub_u32 s72, s72, s60
s_add_u32 m0, s73, 49152
s_add_u32 s67, s72, s75
buffer_load_dwordx4 v10, s[36:39], s67 offen lds
s_add_u32 s72, s72, 28672
s_cmp_ge_u32 s72, 401408
s_cselect_b32 s60, 401408, 0
s_sub_u32 s72, s72, s60
s_add_u32 m0, s73, 53248
s_add_u32 s67, s72, s75
buffer_load_dwordx4 v10, s[36:39], s67 offen lds
s_add_u32 s72, s72, 28672
s_cmp_ge_u32 s72, 401408
s_cselect_b32 s60, 401408, 0
s_sub_u32 s72, s72, s60
L_wo_17:
v_cmp_gt_u32 vcc, 32, v1
v_cvt_pk_bf16_f32 v24, v128, v129
v_cvt_pk_bf16_f32 v25, v130, v131
v_cvt_pk_bf16_f32 v26, v132, v133
v_cvt_pk_bf16_f32 v27, v134, v135
v_cvt_pk_bf16_f32 v28, v136, v137
v_cvt_pk_bf16_f32 v29, v138, v139
v_cvt_pk_bf16_f32 v30, v140, v141
v_cvt_pk_bf16_f32 v31, v142, v143
v_cndmask_b32 v30, 0, v30, vcc
v_cndmask_b32 v31, 0, v31, vcc
v_cvt_pk_bf16_f32 v32, v144, v145
v_cvt_pk_bf16_f32 v33, v146, v147
v_cvt_pk_bf16_f32 v34, v148, v149
v_cvt_pk_bf16_f32 v35, v150, v151
v_cvt_pk_bf16_f32 v36, v152, v153
v_cvt_pk_bf16_f32 v37, v154, v155
v_cvt_pk_bf16_f32 v38, v156, v157
v_cvt_pk_bf16_f32 v39, v158, v159
v_cndmask_b32 v38, 0, v38, vcc
v_cndmask_b32 v39, 0, v39, vcc
s_mov_b32 s63, 0
s_cmp_eq_u32 s6, 7
s_cbranch_scc1 L_p2w_21
s_waitcnt vmcnt(8)
s_branch L_p2c_20
L_p2w_21:
s_waitcnt vmcnt(0)
s_branch L_p2c_20
L_p2_18:
v_min_u32 v243, 7, v1
v_lshlrev_b32 v243, 9, v243
v_add_u32 v243, 4, v243
L_cp_22:
buffer_load_dword v241, v243, s[48:51], s61 offen sc1
s_add_u32 s63, s63, 1
s_waitcnt vmcnt(0)
v_cmp_ne_u32 vcc, s52, v241
s_cmp_lt_u32 s63, 1048576
s_cbranch_scc0 L_cpd_23
s_cbranch_vccnz L_cp_22
L_cpd_23:
buffer_load_dwordx2 v[160:161], v242, s[48:51], s61 offen offset:0 sc1
buffer_load_dwordx2 v[162:163], v242, s[48:51], s61 offen offset:512 sc1
buffer_load_dwordx2 v[164:165], v242, s[48:51], s61 offen offset:1024 sc1
buffer_load_dwordx2 v[166:167], v242, s[48:51], s61 offen offset:1536 sc1
buffer_load_dwordx2 v[168:169], v242, s[48:51], s61 offen offset:2048 sc1
buffer_load_dwordx2 v[170:171], v242, s[48:51], s61 offen offset:2560 sc1
buffer_load_dwordx2 v[172:173], v242, s[48:51], s61 offen offset:3072 sc1
buffer_load_dwordx2 v[174:175], v242, s[48:51], s61 offen offset:3584 sc1
s_waitcnt vmcnt(0)
L_p2c_20:
v_mov_b32 v236, s52
v_mov_b32 v237, s52
v_min3_u32 v236, v236, v161, v163
v_max3_u32 v237, v237, v161, v163
v_min3_u32 v236, v236, v165, v167
v_max3_u32 v237, v237, v165, v167
v_min3_u32 v236, v236, v169, v171
v_max3_u32 v237, v237, v169, v171
v_min3_u32 v236, v236, v173, v175
v_max3_u32 v237, v237, v173, v175
v_cmp_ne_u32 vcc, v236, v237
s_add_u32 s63, s63, 1
s_cmp_lt_u32 s63, 1048576
s_cbranch_scc0 L_p2d_19
s_cbranch_vccnz L_p2_18
L_p2d_19:
v_mov_b32 v40, v160
v_mov_b32 v41, v162
v_mov_b32 v42, v164
v_mov_b32 v43, v166
v_mov_b32 v44, v168
v_mov_b32 v45, v170
v_mov_b32 v46, v172
v_mov_b32 v47, v174
s_nop 1
v_mfma_f32_32x32x16_bf16 v[64:79], v[40:43], v[24:27], 0
v_mfma_f32_32x32x16_bf16 v[64:79], v[44:47], v[28:31], v[64:79]
v_mfma_f32_32x32x16_bf16 v[80:95], v[40:43], v[32:35], 0
v_mfma_f32_32x32x16_bf16 v[80:95], v[44:47], v[36:39], v[80:95]
s_lshl_b32 s61, s5, 2
s_lshl_b32 s59, s57, 1
s_add_u32 s61, s61, s59
s_lshl_b32 s61, s61, 4
s_lshl_b32 s59, s6, 1
s_add_u32 s61, s61, s59
s_add_u32 s61, s61, s58
s_lshl_b32 s61, s61, 11
s_add_u32 s61, s61, 8388608
v_cmp_gt_u32 vcc, 32, v1
s_nop 3
s_nop 1
v_mov_b32 v228, v76
v_mov_b32 v229, v76
s_nop 1
v_permlane32_swap_b32 v228, v229
s_nop 1
v_add_f32 v229, s65, v229
v_rcp_f32 v229, v229
s_nop 0
v_pk_mul_f32 v[64:65], v[64:65], v[228:229] op_sel:[0,1] op_sel_hi:[1,1]
v_pk_mul_f32 v[66:67], v[66:67], v[228:229] op_sel:[0,1] op_sel_hi:[1,1]
v_pk_mul_f32 v[68:69], v[68:69], v[228:229] op_sel:[0,1] op_sel_hi:[1,1]
v_pk_mul_f32 v[70:71], v[70:71], v[228:229] op_sel:[0,1] op_sel_hi:[1,1]
v_pk_mul_f32 v[72:73], v[72:73], v[228:229] op_sel:[0,1] op_sel_hi:[1,1]
v_pk_mul_f32 v[74:75], v[74:75], v[228:229] op_sel:[0,1] op_sel_hi:[1,1]
v_pk_mul_f32 v[76:77], v[76:77], v[228:229] op_sel:[0,1] op_sel_hi:[1,1]
v_pk_mul_f32 v[78:79], v[78:79], v[228:229] op_sel:[0,1] op_sel_hi:[1,1]
v_cvt_pk_bf16_f32 v176, v64, v65
v_cvt_pk_bf16_f32 v177, v66, v67
v_cvt_pk_bf16_f32 v178, v68, v69
v_cvt_pk_bf16_f32 v179, v70, v71
v_cvt_pk_bf16_f32 v180, v72, v73
v_cvt_pk_bf16_f32 v181, v74, v75
v_cvt_pk_bf16_f32 v182, v76, v77
v_cvt_pk_bf16_f32 v183, v78, v79
v_cndmask_b32 v182, 0, v182, vcc
v_cndmask_b32 v183, 0, v183, vcc
buffer_store_dwordx4 v[176:179], v225, s[48:51], s61 offen offset:0 sc1
buffer_store_dwordx4 v[180:183], v225, s[48:51], s61 offen offset:1024 sc1
s_add_u32 s61, s61, 32768
v_mov_b32 v228, v92
v_mov_b32 v229, v92
s_nop 1
v_permlane32_swap_b32 v228, v229
s_nop 1
v_add_f32 v229, s65, v229
v_rcp_f32 v229, v229
s_nop 0
v_pk_mul_f32 v[80:81], v[80:81], v[228:229] op_sel:[0,1] op_sel_hi:[1,1]
v_pk_mul_f32 v[82:83], v[82:83], v[228:229] op_sel:[0,1] op_sel_hi:[1,1]
v_pk_mul_f32 v[84:85], v[84:85], v[228:229] op_sel:[0,1] op_sel_hi:[1,1]
v_pk_mul_f32 v[86:87], v[86:87], v[228:229] op_sel:[0,1] op_sel_hi:[1,1]
v_pk_mul_f32 v[88:89], v[88:89], v[228:229] op_sel:[0,1] op_sel_hi:[1,1]
v_pk_mul_f32 v[90:91], v[90:91], v[228:229] op_sel:[0,1] op_sel_hi:[1,1]
v_pk_mul_f32 v[92:93], v[92:93], v[228:229] op_sel:[0,1] op_sel_hi:[1,1]
v_pk_mul_f32 v[94:95], v[94:95], v[228:229] op_sel:[0,1] op_sel_hi:[1,1]
v_cvt_pk_bf16_f32 v184, v80, v81
v_cvt_pk_bf16_f32 v185, v82, v83
v_cvt_pk_bf16_f32 v186, v84, v85
v_cvt_pk_bf16_f32 v187, v86, v87
v_cvt_pk_bf16_f32 v188, v88, v89
v_cvt_pk_bf16_f32 v189, v90, v91
v_cvt_pk_bf16_f32 v190, v92, v93
v_cvt_pk_bf16_f32 v191, v94, v95
v_cndmask_b32 v190, 0, v190, vcc
v_cndmask_b32 v191, 0, v191, vcc
buffer_store_dwordx4 v[184:187], v225, s[48:51], s61 offen offset:0 sc1
buffer_store_dwordx4 v[188:191], v225, s[48:51], s61 offen offset:1024 sc1
v_lshrrev_b32 v20, 5, v1
v_mul_u32_u24 v20, 14336, v20
v_lshl_add_u32 v20, v7, 2, v20
s_lshl_b32 s60, s5, 7
s_lshl_b32 s61, s57, 6
s_add_u32 s60, s60, s61
s_mul_i32 s74, s60, 3584
s_lshl_b32 s59, s6, 8
s_add_u32 s74, s74, s59
s_lshl_b32 s59, s58, 7
s_add_u32 s74, s74, s59
s_add_u32 s74, s74, 1792
s_lshl_b32 s73, s5, 2
s_add_u32 s73, s73, s4
s_lshl_b32 s73, s73, 15
s_add_u32 s73, s73, 8388608
s_and_b32 s72, s6, 7
s_lshl_b32 s59, s57, 16
v_add_u32 v10, s59, v225
v_min_u32 v240, 7, v1
v_lshlrev_b32 v240, 7, v240
s_lshl_b32 s77, s5, 10
s_add_u32 s77, s77, 212992
v_bfe_u32 v232, v1, 2, 2
v_lshrrev_b32 v233, 5, v1
v_lshl_add_u32 v233, v233, 2, v232
v_lshlrev_b32 v5, 7, v233
v_bfe_u32 v233, v1, 4, 1
v_lshlrev_b32 v233, 1, v233
v_bfe_u32 v234, v1, 1, 1
v_add_u32 v233, v233, v234
s_lshl_b32 s59, s58, 2
v_add_u32 v233, s59, v233
v_lshrrev_b32 v232, 1, v232
v_lshlrev_b32 v232, 2, v232
v_xor_b32 v233, v233, v232
v_lshl_add_u32 v5, v233, 4, v5
v_and_b32 v232, 1, v1
v_lshl_add_u32 v5, v232, 3, v5
s_waitcnt vmcnt(0)
s_barrier
s_cmp_eq_u32 s4, 0
s_cbranch_scc0 L_nofl_24
s_lshl_b32 s59, s6, 7
v_mov_b32 v237, s59
v_mov_b32 v238, s52
s_mov_b64 exec, 1
buffer_store_dword v238, v237, s[48:51], s77 offen sc1
s_mov_b64 exec, -1
L_nofl_24:
s_lshl_b32 s61, s5, 2
s_lshl_b32 s59, s57, 1
s_add_u32 s61, s61, s59
s_lshl_b32 s61, s61, 4
s_lshl_b32 s59, s6, 1
s_add_u32 s61, s61, s59
s_add_u32 s61, s61, s58
s_lshl_b32 s61, s61, 11
s_add_u32 s61, s61, 8388608
v_and_b32 v253, 15, v1
v_lshlrev_b32 v253, 7, v253
v_bfe_u32 v252, v1, 4, 1
v_lshl_add_u32 v253, v252, 15, v253
s_mov_b32 exec_hi, 0
buffer_load_dword v254, v253, s[48:51], s61 offen sc1
s_mov_b32 exec_hi, -1
s_cmp_eq_u32 s6, 7
s_cbranch_scc1 L_bend_25
ds_read_b64_tr_b16 a[0:1], v5 offset:0
ds_read_b64_tr_b16 a[2:3], v5 offset:1024
ds_read_b64_tr_b16 a[4:5], v5 offset:2048
ds_read_b64_tr_b16 a[6:7], v5 offset:3072
ds_read_b64_tr_b16 a[8:9], v5 offset:3584
ds_read_b64_tr_b16 a[10:11], v5 offset:4608
ds_read_b64_tr_b16 a[12:13], v5 offset:5632
ds_read_b64_tr_b16 a[14:15], v5 offset:6656
ds_read_b64_tr_b16 a[16:17], v5 offset:7168
ds_read_b64_tr_b16 a[18:19], v5 offset:8192
ds_read_b64_tr_b16 a[20:21], v5 offset:9216
ds_read_b64_tr_b16 a[22:23], v5 offset:10240
ds_read_b64_tr_b16 a[24:25], v5 offset:10752
ds_read_b64_tr_b16 a[26:27], v5 offset:11776
ds_read_b64_tr_b16 a[28:29], v5 offset:12800
ds_read_b64_tr_b16 a[30:31], v5 offset:13824
ds_read_b64_tr_b16 a[32:33], v5 offset:14336
ds_read_b64_tr_b16 a[34:35], v5 offset:15360
ds_read_b64_tr_b16 a[36:37], v5 offset:16384
ds_read_b64_tr_b16 a[38:39], v5 offset:17408
ds_read_b64_tr_b16 a[40:41], v5 offset:17920
ds_read_b64_tr_b16 a[42:43], v5 offset:18944
ds_read_b64_tr_b16 a[44:45], v5 offset:19968
ds_read_b64_tr_b16 a[46:47], v5 offset:20992
ds_read_b64_tr_b16 a[48:49], v5 offset:21504
ds_read_b64_tr_b16 a[50:51], v5 offset:22528
ds_read_b64_tr_b16 a[52:53], v5 offset:23552
ds_read_b64_tr_b16 a[54:55], v5 offset:24576
ds_read_b64_tr_b16 a[56:57], v5 offset:25088
ds_read_b64_tr_b16 a[58:59], v5 offset:26112
ds_read_b64_tr_b16 a[60:61], v5 offset:27136
ds_read_b64_tr_b16 a[62:63], v5 offset:28160
ds_read_b64_tr_b16 a[64:65], v5 offset:28672
ds_read_b64_tr_b16 a[66:67], v5 offset:29696
ds_read_b64_tr_b16 a[68:69], v5 offset:30720
ds_read_b64_tr_b16 a[70:71], v5 offset:31744
ds_read_b64_tr_b16 a[72:73], v5 offset:32256
ds_read_b64_tr_b16 a[74:75], v5 offset:33280
ds_read_b64_tr_b16 a[76:77], v5 offset:34304
ds_read_b64_tr_b16 a[78:79], v5 offset:35328
ds_read_b64_tr_b16 a[80:81], v5 offset:35840
ds_read_b64_tr_b16 a[82:83], v5 offset:36864
ds_read_b64_tr_b16 a[84:85], v5 offset:37888
ds_read_b64_tr_b16 a[86:87], v5 offset:38912
ds_read_b64_tr_b16 a[88:89], v5 offset:39424
ds_read_b64_tr_b16 a[90:91], v5 offset:40448
ds_read_b64_tr_b16 a[92:93], v5 offset:41472
ds_read_b64_tr_b16 a[94:95], v5 offset:42496
ds_read_b64_tr_b16 a[96:97], v5 offset:43008
ds_read_b64_tr_b16 a[98:99], v5 offset:44032
ds_read_b64_tr_b16 a[100:101], v5 offset:45056
ds_read_b64_tr_b16 a[102:103], v5 offset:46080
ds_read_b64_tr_b16 a[104:105], v5 offset:46592
ds_read_b64_tr_b16 a[106:107], v5 offset:47616
ds_read_b64_tr_b16 a[108:109], v5 offset:48640
ds_read_b64_tr_b16 a[110:111], v5 offset:49664
ds_read_b64_tr_b16 a[112:113], v5 offset:50176
ds_read_b64_tr_b16 a[114:115], v5 offset:51200
ds_read_b64_tr_b16 a[116:117], v5 offset:52224
ds_read_b64_tr_b16 a[118:119], v5 offset:53248
ds_read_b64_tr_b16 a[120:121], v5 offset:53760
ds_read_b64_tr_b16 a[122:123], v5 offset:54784
ds_read_b64_tr_b16 a[124:125], v5 offset:55808
ds_read_b64_tr_b16 a[126:127], v5 offset:56832
s_lshl_b32 s66, s4, 15
s_waitcnt vmcnt(0) lgkmcnt(0)
s_barrier
buffer_load_dword v241, v240, s[48:51], s77 offen sc1
s_add_u32 m0, s66, 0
s_lshl_b32 s67, s72, 12
s_add_u32 s67, s67, s73
buffer_load_dwordx4 v225, s[48:51], s67 offen offset:0 sc1 lds
buffer_load_dwordx4 v225, s[48:51], s67 offen offset:1024 sc1 lds
buffer_load_dwordx4 v225, s[48:51], s67 offen offset:2048 sc1 lds
buffer_load_dwordx4 v225, s[48:51], s67 offen offset:3072 sc1 lds
s_add_u32 s72, s72, 1
s_and_b32 s72, s72, 7
s_waitcnt vmcnt(4)
s_mov_b32 s63, 0
s_branch L_flc_28
L_fl_26:
buffer_load_dword v241, v240, s[48:51], s77 offen sc1
s_waitcnt vmcnt(0)
L_flc_28:
v_cmp_ne_u32 vcc, s52, v241
s_add_u32 s63, s63, 1
s_cmp_lt_u32 s63, 1048576
s_cbranch_scc0 L_fld_27
s_cbranch_vccnz L_fl_26
L_fld_27:
s_cmp_eq_u32 s5, 15
s_cbranch_scc0 L_noep_29
s_cmp_eq_u32 s6, 0
s_cbranch_scc0 L_noep_29
s_cmp_eq_u32 s4, 0
s_cbranch_scc0 L_noep_29
v_mov_b32 v237, 0
v_mov_b32 v238, s52
s_mov_b64 exec, 1
buffer_store_dword v238, v237, s[48:51], 0 offen offset:128 sc1
s_mov_b64 exec, -1
s_waitcnt vmcnt(0)
L_noep_29:
s_add_u32 m0, s66, 4096
s_lshl_b32 s67, s72, 12
s_add_u32 s67, s67, s73
buffer_load_dwordx4 v225, s[48:51], s67 offen offset:0 sc1 lds
buffer_load_dwordx4 v225, s[48:51], s67 offen offset:1024 sc1 lds
buffer_load_dwordx4 v225, s[48:51], s67 offen offset:2048 sc1 lds
buffer_load_dwordx4 v225, s[48:51], s67 offen offset:3072 sc1 lds
s_add_u32 s72, s72, 1
s_and_b32 s72, s72, 7
s_add_u32 m0, s66, 8192
s_lshl_b32 s67, s72, 12
s_add_u32 s67, s67, s73
buffer_load_dwordx4 v225, s[48:51], s67 offen offset:0 sc1 lds
buffer_load_dwordx4 v225, s[48:51], s67 offen offset:1024 sc1 lds
buffer_load_dwordx4 v225, s[48:51], s67 offen offset:2048 sc1 lds
buffer_load_dwordx4 v225, s[48:51], s67 offen offset:3072 sc1 lds
s_add_u32 s72, s72, 1
s_and_b32 s72, s72, 7
s_waitcnt vmcnt(8)
s_barrier
ds_read_b128 v[64:67], v10 offset:0
ds_read_b128 v[68:71], v10 offset:32768
ds_read_b128 v[72:75], v10 offset:1024
ds_read_b128 v[76:79], v10 offset:33792
s_waitcnt lgkmcnt(0)
v_mfma_f32_32x32x16_bf16 v[32:47], v[64:67], a[0:3], 0
ds_read_b128 v[80:83], v10 offset:2048
ds_read_b128 v[84:87], v10 offset:34816
v_mfma_f32_32x32x16_bf16 v[48:63], v[68:71], a[0:3], 0
ds_read_b128 v[88:91], v10 offset:3072
ds_read_b128 v[92:95], v10 offset:35840
v_mfma_f32_32x32x16_bf16 v[32:47], v[72:75], a[4:7], v[32:47]
s_add_u32 m0, s66, 12288
s_lshl_b32 s67, s72, 12
s_add_u32 s67, s67, s73
buffer_load_dwordx4 v225, s[48:51], s67 offen offset:0 sc1 lds
buffer_load_dwordx4 v225, s[48:51], s67 offen offset:1024 sc1 lds
v_mfma_f32_32x32x16_bf16 v[48:63], v[76:79], a[4:7], v[48:63]
buffer_load_dwordx4 v225, s[48:51], s67 offen offset:2048 sc1 lds
buffer_load_dwordx4 v225, s[48:51], s67 offen offset:3072 sc1 lds
s_add_u32 s72, s72, 1
s_and_b32 s72, s72, 7
s_waitcnt lgkmcnt(0)
s_waitcnt vmcnt(8)
s_barrier
v_mfma_f32_32x32x16_bf16 v[32:47], v[80:83], a[8:11], v[32:47]
ds_read_b128 v[64:67], v10 offset:4096
ds_read_b128 v[68:71], v10 offset:36864
v_mfma_f32_32x32x16_bf16 v[48:63], v[84:87], a[8:11], v[48:63]
ds_read_b128 v[72:75], v10 offset:5120
ds_read_b128 v[76:79], v10 offset:37888
v_mfma_f32_32x32x16_bf16 v[32:47], v[88:91], a[12:15], v[32:47]
s_add_u32 m0, s66, 16384
s_lshl_b32 s67, s72, 12
s_add_u32 s67, s67, s73
buffer_load_dwordx4 v225, s[48:51], s67 offen offset:0 sc1 lds
v_mfma_f32_32x32x16_bf16 v[48:63], v[92:95], a[12:15], v[48:63]
buffer_load_dwordx4 v225, s[48:51], s67 offen offset:1024 sc1 lds
s_waitcnt lgkmcnt(0)
v_mfma_f32_32x32x16_bf16 v[32:47], v[64:67], a[16:19], v[32:47]
ds_read_b128 v[80:83], v10 offset:6144
ds_read_b128 v[84:87], v10 offset:38912
v_mfma_f32_32x32x16_bf16 v[48:63], v[68:71], a[16:19], v[48:63]
ds_read_b128 v[88:91], v10 offset:7168
ds_read_b128 v[92:95], v10 offset:39936
v_mfma_f32_32x32x16_bf16 v[32:47], v[72:75], a[20:23], v[32:47]
buffer_load_dwordx4 v225, s[48:51], s67 offen offset:2048 sc1 lds
v_mfma_f32_32x32x16_bf16 v[48:63], v[76:79], a[20:23], v[48:63]
buffer_load_dwordx4 v225, s[48:51], s67 offen offset:3072 sc1 lds
s_add_u32 s72, s72, 1
s_and_b32 s72, s72, 7
s_waitcnt lgkmcnt(0)
s_waitcnt vmcnt(8)
s_barrier
v_mfma_f32_32x32x16_bf16 v[32:47], v[80:83], a[24:27], v[32:47]
ds_read_b128 v[64:67], v10 offset:8192
ds_read_b128 v[68:71], v10 offset:40960
v_mfma_f32_32x32x16_bf16 v[48:63], v[84:87], a[24:27], v[48:63]
ds_read_b128 v[72:75], v10 offset:9216
ds_read_b128 v[76:79], v10 offset:41984
v_mfma_f32_32x32x16_bf16 v[32:47], v[88:91], a[28:31], v[32:47]
s_add_u32 m0, s66, 20480
s_lshl_b32 s67, s72, 12
s_add_u32 s67, s67, s73
buffer_load_dwordx4 v225, s[48:51], s67 offen offset:0 sc1 lds
v_mfma_f32_32x32x16_bf16 v[48:63], v[92:95], a[28:31], v[48:63]
buffer_load_dwordx4 v225, s[48:51], s67 offen offset:1024 sc1 lds
s_waitcnt lgkmcnt(0)
v_mfma_f32_32x32x16_bf16 v[32:47], v[64:67], a[32:35], v[32:47]
ds_read_b128 v[80:83], v10 offset:10240
ds_read_b128 v[84:87], v10 offset:43008
v_mfma_f32_32x32x16_bf16 v[48:63], v[68:71], a[32:35], v[48:63]
ds_read_b128 v[88:91], v10 offset:11264
ds_read_b128 v[92:95], v10 offset:44032
v_mfma_f32_32x32x16_bf16 v[32:47], v[72:75], a[36:39], v[32:47]
buffer_load_dwordx4 v225, s[48:51], s67 offen offset:2048 sc1 lds
v_mfma_f32_32x32x16_bf16 v[48:63], v[76:79], a[36:39], v[48:63]
buffer_load_dwordx4 v225, s[48:51], s67 offen offset:3072 sc1 lds
s_add_u32 s72, s72, 1
s_and_b32 s72, s72, 7
s_waitcnt lgkmcnt(0)
s_waitcnt vmcnt(8)
s_barrier
v_mfma_f32_32x32x16_bf16 v[32:47], v[80:83], a[40:43], v[32:47]
ds_read_b128 v[64:67], v10 offset:12288
ds_read_b128 v[68:71], v10 offset:45056
v_mfma_f32_32x32x16_bf16 v[48:63], v[84:87], a[40:43], v[48:63]
ds_read_b128 v[72:75], v10 offset:13312
ds_read_b128 v[76:79], v10 offset:46080
v_mfma_f32_32x32x16_bf16 v[32:47], v[88:91], a[44:47], v[32:47]
s_add_u32 m0, s66, 24576
s_lshl_b32 s67, s72, 12
s_add_u32 s67, s67, s73
buffer_load_dwordx4 v225, s[48:51], s67 offen offset:0 sc1 lds
v_mfma_f32_32x32x16_bf16 v[48:63], v[92:95], a[44:47], v[48:63]
buffer_load_dwordx4 v225, s[48:51], s67 offen offset:1024 sc1 lds
s_waitcnt lgkmcnt(0)
v_mfma_f32_32x32x16_bf16 v[32:47], v[64:67], a[48:51], v[32:47]
ds_read_b128 v[80:83], v10 offset:14336
ds_read_b128 v[84:87], v10 offset:47104
v_mfma_f32_32x32x16_bf16 v[48:63], v[68:71], a[48:51], v[48:63]
ds_read_b128 v[88:91], v10 offset:15360
ds_read_b128 v[92:95], v10 offset:48128
v_mfma_f32_32x32x16_bf16 v[32:47], v[72:75], a[52:55], v[32:47]
buffer_load_dwordx4 v225, s[48:51], s67 offen offset:2048 sc1 lds
v_mfma_f32_32x32x16_bf16 v[48:63], v[76:79], a[52:55], v[48:63]
buffer_load_dwordx4 v225, s[48:51], s67 offen offset:3072 sc1 lds
s_add_u32 s72, s72, 1
s_and_b32 s72, s72, 7
s_waitcnt lgkmcnt(0)
s_waitcnt vmcnt(8)
s_barrier
v_mfma_f32_32x32x16_bf16 v[32:47], v[80:83], a[56:59], v[32:47]
ds_read_b128 v[64:67], v10 offset:16384
ds_read_b128 v[68:71], v10 offset:49152
v_mfma_f32_32x32x16_bf16 v[48:63], v[84:87], a[56:59], v[48:63]
ds_read_b128 v[72:75], v10 offset:17408
ds_read_b128 v[76:79], v10 offset:50176
v_mfma_f32_32x32x16_bf16 v[32:47], v[88:91], a[60:63], v[32:47]
s_add_u32 m0, s66, 28672
s_lshl_b32 s67, s72, 12
s_add_u32 s67, s67, s73
buffer_load_dwordx4 v225, s[48:51], s67 offen offset:0 sc1 lds
v_mfma_f32_32x32x16_bf16 v[48:63], v[92:95], a[60:63], v[48:63]
buffer_load_dwordx4 v225, s[48:51], s67 offen offset:1024 sc1 lds
s_waitcnt lgkmcnt(0)
v_mfma_f32_32x32x16_bf16 v[32:47], v[64:67], a[64:67], v[32:47]
ds_read_b128 v[80:83], v10 offset:18432
ds_read_b128 v[84:87], v10 offset:51200
v_mfma_f32_32x32x16_bf16 v[48:63], v[68:71], a[64:67], v[48:63]
ds_read_b128 v[88:91], v10 offset:19456
ds_read_b128 v[92:95], v10 offset:52224
v_mfma_f32_32x32x16_bf16 v[32:47], v[72:75], a[68:71], v[32:47]
buffer_load_dwordx4 v225, s[48:51], s67 offen offset:2048 sc1 lds
v_mfma_f32_32x32x16_bf16 v[48:63], v[76:79], a[68:71], v[48:63]
buffer_load_dwordx4 v225, s[48:51], s67 offen offset:3072 sc1 lds
s_add_u32 s72, s72, 1
s_and_b32 s72, s72, 7
s_waitcnt lgkmcnt(0)
s_waitcnt vmcnt(8)
s_barrier
v_mfma_f32_32x32x16_bf16 v[32:47], v[80:83], a[72:75], v[32:47]
ds_read_b128 v[64:67], v10 offset:20480
ds_read_b128 v[68:71], v10 offset:53248
v_mfma_f32_32x32x16_bf16 v[48:63], v[84:87], a[72:75], v[48:63]
ds_read_b128 v[72:75], v10 offset:21504
ds_read_b128 v[76:79], v10 offset:54272
v_mfma_f32_32x32x16_bf16 v[32:47], v[88:91], a[76:79], v[32:47]
v_mfma_f32_32x32x16_bf16 v[48:63], v[92:95], a[76:79], v[48:63]
s_waitcnt lgkmcnt(0)
v_mfma_f32_32x32x16_bf16 v[32:47], v[64:67], a[80:83], v[32:47]
ds_read_b128 v[80:83], v10 offset:22528
ds_read_b128 v[84:87], v10 offset:55296
v_mfma_f32_32x32x16_bf16 v[48:63], v[68:71], a[80:83], v[48:63]
ds_read_b128 v[88:91], v10 offset:23552
ds_read_b128 v[92:95], v10 offset:56320
v_mfma_f32_32x32x16_bf16 v[32:47], v[72:75], a[84:87], v[32:47]
v_mfma_f32_32x32x16_bf16 v[48:63], v[76:79], a[84:87], v[48:63]
s_waitcnt lgkmcnt(0)
s_waitcnt vmcnt(4)
s_barrier
v_mfma_f32_32x32x16_bf16 v[32:47], v[80:83], a[88:91], v[32:47]
ds_read_b128 v[64:67], v10 offset:24576
ds_read_b128 v[68:71], v10 offset:57344
v_mfma_f32_32x32x16_bf16 v[48:63], v[84:87], a[88:91], v[48:63]
ds_read_b128 v[72:75], v10 offset:25600
ds_read_b128 v[76:79], v10 offset:58368
v_mfma_f32_32x32x16_bf16 v[32:47], v[88:91], a[92:95], v[32:47]
v_mfma_f32_32x32x16_bf16 v[48:63], v[92:95], a[92:95], v[48:63]
s_waitcnt lgkmcnt(0)
v_mfma_f32_32x32x16_bf16 v[32:47], v[64:67], a[96:99], v[32:47]
ds_read_b128 v[80:83], v10 offset:26624
ds_read_b128 v[84:87], v10 offset:59392
v_mfma_f32_32x32x16_bf16 v[48:63], v[68:71], a[96:99], v[48:63]
ds_read_b128 v[88:91], v10 offset:27648
ds_read_b128 v[92:95], v10 offset:60416
v_mfma_f32_32x32x16_bf16 v[32:47], v[72:75], a[100:103], v[32:47]
v_mfma_f32_32x32x16_bf16 v[48:63], v[76:79], a[100:103], v[48:63]
s_waitcnt lgkmcnt(0)
s_waitcnt vmcnt(0)
s_barrier
v_mfma_f32_32x32x16_bf16 v[32:47], v[80:83], a[104:107], v[32:47]
ds_read_b128 v[64:67], v10 offset:28672
ds_read_b128 v[68:71], v10 offset:61440
v_mfma_f32_32x32x16_bf16 v[48:63], v[84:87], a[104:107], v[48:63]
ds_read_b128 v[72:75], v10 offset:29696
ds_read_b128 v[76:79], v10 offset:62464
v_mfma_f32_32x32x16_bf16 v[32:47], v[88:91], a[108:111], v[32:47]
v_mfma_f32_32x32x16_bf16 v[48:63], v[92:95], a[108:111], v[48:63]
s_waitcnt lgkmcnt(0)
v_mfma_f32_32x32x16_bf16 v[32:47], v[64:67], a[112:115], v[32:47]
ds_read_b128 v[80:83], v10 offset:30720
ds_read_b128 v[84:87], v10 offset:63488
v_mfma_f32_32x32x16_bf16 v[48:63], v[68:71], a[112:115], v[48:63]
ds_read_b128 v[88:91], v10 offset:31744
ds_read_b128 v[92:95], v10 offset:64512
v_mfma_f32_32x32x16_bf16 v[32:47], v[72:75], a[116:119], v[32:47]
v_mfma_f32_32x32x16_bf16 v[48:63], v[76:79], a[116:119], v[48:63]
s_waitcnt lgkmcnt(0)
v_mfma_f32_32x32x16_bf16 v[32:47], v[80:83], a[120:123], v[32:47]
v_mfma_f32_32x32x16_bf16 v[48:63], v[84:87], a[120:123], v[48:63]
v_mfma_f32_32x32x16_bf16 v[32:47], v[88:91], a[124:127], v[32:47]
v_mfma_f32_32x32x16_bf16 v[48:63], v[92:95], a[124:127], v[48:63]
s_nop 7
s_nop 3
s_add_u32 s59, s74, 0
buffer_store_dword v32, v20, s[68:71], s59 offen sc0 sc1
s_add_u32 s59, s74, 3584
buffer_store_dword v33, v20, s[68:71], s59 offen sc0 sc1
s_add_u32 s59, s74, 7168
buffer_store_dword v34, v20, s[68:71], s59 offen sc0 sc1
s_add_u32 s59, s74, 10752
buffer_store_dword v35, v20, s[68:71], s59 offen sc0 sc1
s_add_u32 s59, s74, 28672
buffer_store_dword v36, v20, s[68:71], s59 offen sc0 sc1
s_add_u32 s59, s74, 32256
buffer_store_dword v37, v20, s[68:71], s59 offen sc0 sc1
s_add_u32 s59, s74, 35840
buffer_store_dword v38, v20, s[68:71], s59 offen sc0 sc1
s_add_u32 s59, s74, 39424
buffer_store_dword v39, v20, s[68:71], s59 offen sc0 sc1
s_add_u32 s59, s74, 57344
buffer_store_dword v40, v20, s[68:71], s59 offen sc0 sc1
s_add_u32 s59, s74, 60928
buffer_store_dword v41, v20, s[68:71], s59 offen sc0 sc1
s_add_u32 s59, s74, 64512
buffer_store_dword v42, v20, s[68:71], s59 offen sc0 sc1
s_add_u32 s59, s74, 68096
buffer_store_dword v43, v20, s[68:71], s59 offen sc0 sc1
s_add_u32 s59, s74, 86016
buffer_store_dword v44, v20, s[68:71], s59 offen sc0 sc1
s_add_u32 s59, s74, 89600
buffer_store_dword v45, v20, s[68:71], s59 offen sc0 sc1
s_add_u32 s59, s74, 93184
buffer_store_dword v46, v20, s[68:71], s59 offen sc0 sc1
s_add_u32 s59, s74, 96768
buffer_store_dword v47, v20, s[68:71], s59 offen sc0 sc1
s_add_u32 s59, s74, 114688
buffer_store_dword v48, v20, s[68:71], s59 offen sc0 sc1
s_add_u32 s59, s74, 118272
buffer_store_dword v49, v20, s[68:71], s59 offen sc0 sc1
s_add_u32 s59, s74, 121856
buffer_store_dword v50, v20, s[68:71], s59 offen sc0 sc1
s_add_u32 s59, s74, 125440
buffer_store_dword v51, v20, s[68:71], s59 offen sc0 sc1
s_add_u32 s59, s74, 143360
buffer_store_dword v52, v20, s[68:71], s59 offen sc0 sc1
s_add_u32 s59, s74, 146944
buffer_store_dword v53, v20, s[68:71], s59 offen sc0 sc1
s_add_u32 s59, s74, 150528
buffer_store_dword v54, v20, s[68:71], s59 offen sc0 sc1
s_add_u32 s59, s74, 154112
buffer_store_dword v55, v20, s[68:71], s59 offen sc0 sc1
s_add_u32 s59, s74, 172032
buffer_store_dword v56, v20, s[68:71], s59 offen sc0 sc1
s_add_u32 s59, s74, 175616
buffer_store_dword v57, v20, s[68:71], s59 offen sc0 sc1
s_add_u32 s59, s74, 179200
buffer_store_dword v58, v20, s[68:71], s59 offen sc0 sc1
s_add_u32 s59, s74, 182784
buffer_store_dword v59, v20, s[68:71], s59 offen sc0 sc1
s_add_u32 s59, s74, 200704
buffer_store_dword v60, v20, s[68:71], s59 offen sc0 sc1
s_add_u32 s59, s74, 204288
buffer_store_dword v61, v20, s[68:71], s59 offen sc0 sc1
s_add_u32 s59, s74, 207872
buffer_store_dword v62, v20, s[68:71], s59 offen sc0 sc1
s_add_u32 s59, s74, 211456
buffer_store_dword v63, v20, s[68:71], s59 offen sc0 sc1
L_bend_25:
s_endpgm
L_roleA:
s_cmp_eq_u32 s6, 7
s_cbranch_scc1 L_exit
s_and_b32 s58, s4, 1
s_lshr_b32 s57, s4, 1
v_and_b32 v29, 31, v1
v_and_b32 v196, 7, v1
v_lshrrev_b32 v197, 4, v1
v_xor_b32 v198, v196, v197
v_lshlrev_b32 v198, 4, v198
v_xor_b32 v199, 64, v198
v_and_b32 v200, 32, v1
v_bfe_u32 v201, v1, 3, 2
v_add_u32 v200, v200, v201
s_lshl_b32 s59, s57, 6
s_lshl_b32 s60, s58, 4
s_add_u32 s59, s59, s60
v_add_u32 v200, s59, v200
v_mul_u32_u24 v200, 896, v200
v_add_u32 v10, v200, v198
v_add_u32 v11, v200, v199
v_add_u32 v11, 2560, v11
v_add_u32 v12, v200, v198
v_add_u32 v12, 5120, v12
v_add_u32 v13, v200, v199
v_add_u32 v13, 7680, v13
v_lshrrev_b32 v200, 3, v1
s_lshl_b32 s59, s57, 5
v_add_u32 v200, s59, v200
v_mul_u32_u24 v200, 896, v200
v_add_u32 v14, v200, v198
v_add_u32 v15, v200, v199
v_add_u32 v15, 6144, v15
v_add_u32 v16, v200, v198
v_add_u32 v16, 12288, v16
v_add_u32 v17, v200, v199
v_add_u32 v17, 18432, v17
s_mul_i32 s54, s5, 114688
s_mul_i32 s55, s6, 57344
s_lshl_b32 s56, s4, 12
s_add_u32 s53, s5, s6
s_cmp_ge_u32 s53, 14
s_cselect_b32 s59, 14, 0
s_sub_u32 s53, s53, s59
s_cmp_ge_u32 s53, 7
s_cselect_b32 s59, 7, 0
s_sub_u32 s53, s53, s59
s_cmp_ge_u32 s53, 7
s_cselect_b32 s59, 7, 0
s_sub_u32 s53, s53, s59
s_lshl_b32 s53, s53, 7
s_lshl_b32 s59, s6, 6
s_lshl_b32 s60, s58, 5
s_add_u32 s59, s59, s60
v_add_u32 v192, s59, v29
v_lshlrev_b32 v192, 1, v192
v_mov_b32 v30, 0
s_waitcnt lgkmcnt(0)
s_mov_b32 s48, s36
s_and_b32 s49, s37, 0xffff
s_mov_b32 s50, 11534336
s_mov_b32 s51, 0x00020000
buffer_load_dword v31, v30, s[48:51], 0 offen offset:0 sc1
global_load_ushort v193, v192, s[10:11]
global_load_ushort v194, v192, s[12:13]
global_load_ushort v195, v192, s[22:23]
s_mov_b32 s40, s8
s_and_b32 s41, s9, 0xffff
s_mov_b32 s42, 1835008
s_mov_b32 s43, 0x00020000
s_cmp_eq_u32 s58, 0
s_cselect_b32 s44, s14, s16
s_cselect_b32 s45, s15, s17
s_and_b32 s45, s45, 0xffff
s_mov_b32 s46, 401408
s_mov_b32 s47, 0x00020000
s_add_u32 m0, s56, 0
s_add_u32 s67, s54, s53
buffer_load_dwordx4 v10, s[40:43], s67 offen offset:0 lds
buffer_load_dwordx4 v11, s[40:43], s67 offen offset:1024 lds
buffer_load_dwordx4 v12, s[40:43], s67 offen offset:2048 lds
buffer_load_dwordx4 v13, s[40:43], s67 offen offset:3072 lds
s_add_u32 m0, s56, 49152
s_add_u32 s67, s55, s53
buffer_load_dwordx4 v14, s[44:47], s67 offen offset:0 lds
buffer_load_dwordx4 v15, s[44:47], s67 offen offset:1024 lds
buffer_load_dwordx4 v16, s[44:47], s67 offen offset:2048 lds
buffer_load_dwordx4 v17, s[44:47], s67 offen offset:3072 lds
s_add_u32 s53, s53, 128
s_cmp_ge_u32 s53, 896
s_cselect_b32 s60, 896, 0
s_sub_u32 s53, s53, s60
s_mov_b32 s68, s32
s_and_b32 s69, s33, 0xffff
s_mov_b32 s70, 7340032
s_mov_b32 s71, 0x00020000
v_lshrrev_b32 v200, 5, v1
v_bfe_u32 v201, v1, 1, 3
v_lshlrev_b32 v202, 7, v29
s_lshl_b32 s59, s57, 13
s_lshl_b32 s60, s58, 13
s_add_u32 s60, s60, 49152
v_add_u32 v203, 0, v200
v_xor_b32 v203, v203, v201
v_lshl_add_u32 v203, v203, 4, v202
v_add_u32 v2, s59, v203
v_add_u32 v6, s60, v203
v_add_u32 v203, 2, v200
v_xor_b32 v203, v203, v201
v_lshl_add_u32 v203, v203, 4, v202
v_add_u32 v3, s59, v203
v_add_u32 v7, s60, v203
v_add_u32 v203, 4, v200
v_xor_b32 v203, v203, v201
v_lshl_add_u32 v203, v203, 4, v202
v_add_u32 v4, s59, v203
v_add_u32 v8, s60, v203
v_add_u32 v203, 6, v200
v_xor_b32 v203, v203, v201
v_lshl_add_u32 v203, v203, 4, v202
v_add_u32 v5, s59, v203
v_add_u32 v9, s60, v203
s_mul_i32 s59, s7, 112
s_mul_i32 s60, s58, 56
s_add_u32 s59, s59, s60
v_add_u32 v253, s59, v1
v_lshlrev_b32 v253, 7, v253
s_cmp_eq_u32 s57, 0
s_cselect_b32 s36, s18, s20
s_cselect_b32 s37, s19, s21
s_and_b32 s37, s37, 0xffff
s_mov_b32 s38, 401408
s_mov_b32 s39, 0x00020000
s_add_u32 m0, s56, 16384
s_add_u32 s67, s54, s53
buffer_load_dwordx4 v10, s[40:43], s67 offen offset:0 lds
buffer_load_dwordx4 v11, s[40:43], s67 offen offset:1024 lds
buffer_load_dwordx4 v12, s[40:43], s67 offen offset:2048 lds
buffer_load_dwordx4 v13, s[40:43], s67 offen offset:3072 lds
s_add_u32 m0, s56, 65536
s_add_u32 s67, s55, s53
buffer_load_dwordx4 v14, s[44:47], s67 offen offset:0 lds
buffer_load_dwordx4 v15, s[44:47], s67 offen offset:1024 lds
buffer_load_dwordx4 v16, s[44:47], s67 offen offset:2048 lds
buffer_load_dwordx4 v17, s[44:47], s67 offen offset:3072 lds
s_add_u32 s53, s53, 128
s_cmp_ge_u32 s53, 896
s_cselect_b32 s60, 896, 0
s_sub_u32 s53, s53, s60
s_waitcnt vmcnt(8)
s_barrier
ds_read_b128 v[32:35], v2 offset:0
ds_read_b128 v[40:43], v6 offset:0
ds_read_b128 v[44:47], v6 offset:4096
ds_read_b128 v[36:39], v2 offset:4096
s_waitcnt lgkmcnt(0)
v_mfma_f32_32x32x16_bf16 v[64:79], v[32:35], v[40:43], 0
ds_read_b128 v[48:51], v3 offset:0
ds_read_b128 v[56:59], v7 offset:0
v_mfma_f32_32x32x16_bf16 v[80:95], v[32:35], v[44:47], 0
ds_read_b128 v[60:63], v7 offset:4096
ds_read_b128 v[52:55], v3 offset:4096
v_mfma_f32_32x32x16_bf16 v[96:111], v[36:39], v[40:43], 0
s_add_u32 m0, s56, 32768
s_add_u32 s67, s54, s53
buffer_load_dwordx4 v10, s[40:43], s67 offen offset:0 lds
buffer_load_dwordx4 v11, s[40:43], s67 offen offset:1024 lds
v_mfma_f32_32x32x16_bf16 v[112:127], v[36:39], v[44:47], 0
buffer_load_dwordx4 v12, s[40:43], s67 offen offset:2048 lds
s_waitcnt lgkmcnt(0)
v_mfma_f32_32x32x16_bf16 v[64:79], v[48:51], v[56:59], v[64:79]
ds_read_b128 v[32:35], v4 offset:0
ds_read_b128 v[40:43], v8 offset:0
v_mfma_f32_32x32x16_bf16 v[80:95], v[48:51], v[60:63], v[80:95]
ds_read_b128 v[44:47], v8 offset:4096
ds_read_b128 v[36:39], v4 offset:4096
v_mfma_f32_32x32x16_bf16 v[96:111], v[52:55], v[56:59], v[96:111]
buffer_load_dwordx4 v13, s[40:43], s67 offen offset:3072 lds
s_add_u32 m0, s56, 81920
s_add_u32 s67, s55, s53
buffer_load_dwordx4 v14, s[44:47], s67 offen offset:0 lds
buffer_load_dwordx4 v15, s[44:47], s67 offen offset:1024 lds
v_mfma_f32_32x32x16_bf16 v[112:127], v[52:55], v[60:63], v[112:127]
v_readfirstlane_b32 s52, v31
s_nop 3
s_mul_i32 s52, s52, 2654435761
s_add_u32 s52, s52, 2135587861
v_lshlrev_b32 v193, 16, v193
v_lshlrev_b32 v194, 16, v194
v_lshlrev_b32 v195, 16, v195
v_mul_f32 v196, 0x3fb8aa3b, v195
s_waitcnt lgkmcnt(0)
v_mfma_f32_32x32x16_bf16 v[64:79], v[32:35], v[40:43], v[64:79]
ds_read_b128 v[48:51], v5 offset:0
ds_read_b128 v[56:59], v9 offset:0
v_mfma_f32_32x32x16_bf16 v[80:95], v[32:35], v[44:47], v[80:95]
ds_read_b128 v[60:63], v9 offset:4096
ds_read_b128 v[52:55], v5 offset:4096
v_mfma_f32_32x32x16_bf16 v[96:111], v[36:39], v[40:43], v[96:111]
buffer_load_dwordx4 v16, s[44:47], s67 offen offset:2048 lds
buffer_load_dwordx4 v17, s[44:47], s67 offen offset:3072 lds
s_add_u32 s53, s53, 128
s_cmp_ge_u32 s53, 896
s_cselect_b32 s60, 896, 0
s_sub_u32 s53, s53, s60
v_mfma_f32_32x32x16_bf16 v[112:127], v[36:39], v[44:47], v[112:127]
v_exp_f32 v196, v196
s_nop 0
v_cvt_pk_bf16_f32 v196, v196, v196
v_and_b32 v196, 0xffff0000, v196
v_mul_f32 v197, v196, v193
v_mul_f32 v198, v196, v194
v_mul_f32 v197, 0x3fb8aa3b, v197
v_mul_f32 v198, 0x3e22f983, v198
s_waitcnt lgkmcnt(0)
s_waitcnt vmcnt(8)
s_barrier
v_mfma_f32_32x32x16_bf16 v[64:79], v[48:51], v[56:59], v[64:79]
ds_read_b128 v[32:35], v2 offset:16384
ds_read_b128 v[40:43], v6 offset:16384
v_mfma_f32_32x32x16_bf16 v[80:95], v[48:51], v[60:63], v[80:95]
ds_read_b128 v[44:47], v6 offset:20480
ds_read_b128 v[36:39], v2 offset:20480
v_mfma_f32_32x32x16_bf16 v[96:111], v[52:55], v[56:59], v[96:111]
s_add_u32 m0, s56, 0
s_add_u32 s67, s54, s53
buffer_load_dwordx4 v10, s[40:43], s67 offen offset:0 lds
buffer_load_dwordx4 v11, s[40:43], s67 offen offset:1024 lds
v_mfma_f32_32x32x16_bf16 v[112:127], v[52:55], v[60:63], v[112:127]
v_exp_f32 v197, v197
v_fract_f32 v198, v198
v_cos_f32 v18, v198
v_sin_f32 v19, v198
s_nop 0
v_mul_f32 v18, v18, v197
v_mul_f32 v19, v19, v197
v_sub_f32 v20, 0, v19
s_waitcnt lgkmcnt(0)
v_mfma_f32_32x32x16_bf16 v[64:79], v[32:35], v[40:43], v[64:79]
ds_read_b128 v[48:51], v3 offset:16384
ds_read_b128 v[56:59], v7 offset:16384
v_mfma_f32_32x32x16_bf16 v[80:95], v[32:35], v[44:47], v[80:95]
ds_read_b128 v[60:63], v7 offset:20480
ds_read_b128 v[52:55], v3 offset:20480
v_mfma_f32_32x32x16_bf16 v[96:111], v[36:39], v[40:43], v[96:111]
buffer_load_dwordx4 v12, s[40:43], s67 offen offset:2048 lds
buffer_load_dwordx4 v13, s[40:43], s67 offen offset:3072 lds
v_mfma_f32_32x32x16_bf16 v[112:127], v[36:39], v[44:47], v[112:127]
v_add_f32 v196, -1.0, v18
v_mul_f32 v197, v193, v193
v_fmac_f32 v197, v194, v194
v_rcp_f32 v197, v197
v_mul_f32 v30, v196, v193
v_fmac_f32 v30, v19, v194
v_mul_f32 v31, v19, v193
v_fma_f32 v31, -v196, v194, v31
v_add_f32 v197, v197, v197
s_waitcnt lgkmcnt(0)
v_mfma_f32_32x32x16_bf16 v[64:79], v[48:51], v[56:59], v[64:79]
ds_read_b128 v[32:35], v4 offset:16384
ds_read_b128 v[40:43], v8 offset:16384
v_mfma_f32_32x32x16_bf16 v[80:95], v[48:51], v[60:63], v[80:95]
ds_read_b128 v[44:47], v8 offset:20480
ds_read_b128 v[36:39], v4 offset:20480
v_mfma_f32_32x32x16_bf16 v[96:111], v[52:55], v[56:59], v[96:111]
s_add_u32 m0, s56, 49152
s_add_u32 s67, s55, s53
buffer_load_dwordx4 v14, s[44:47], s67 offen offset:0 lds
buffer_load_dwordx4 v15, s[44:47], s67 offen offset:1024 lds
v_mfma_f32_32x32x16_bf16 v[112:127], v[52:55], v[60:63], v[112:127]
v_mul_f32 v30, v30, v197
v_mul_f32 v31, v31, v197
v_mul_f32 v196, v18, v18
v_mul_f32 v197, v18, v19
v_fma_f32 v196, -v19, v19, v196
v_add_f32 v197, v197, v197
v_mul_f32 v198, v196, v196
v_mul_f32 v199, v196, v197
s_waitcnt lgkmcnt(0)
v_mfma_f32_32x32x16_bf16 v[64:79], v[32:35], v[40:43], v[64:79]
ds_read_b128 v[48:51], v5 offset:16384
ds_read_b128 v[56:59], v9 offset:16384
v_mfma_f32_32x32x16_bf16 v[80:95], v[32:35], v[44:47], v[80:95]
ds_read_b128 v[60:63], v9 offset:20480
ds_read_b128 v[52:55], v5 offset:20480
v_mfma_f32_32x32x16_bf16 v[96:111], v[36:39], v[40:43], v[96:111]
buffer_load_dwordx4 v16, s[44:47], s67 offen offset:2048 lds
buffer_load_dwordx4 v17, s[44:47], s67 offen offset:3072 lds
s_add_u32 s53, s53, 128
s_cmp_ge_u32 s53, 896
s_cselect_b32 s60, 896, 0
s_sub_u32 s53, s53, s60
v_mfma_f32_32x32x16_bf16 v[112:127], v[36:39], v[44:47], v[112:127]
v_fma_f32 v198, -v197, v197, v198
v_add_f32 v199, v199, v199
v_mul_f32 v196, v198, v198
v_mul_f32 v197, v198, v199
v_fma_f32 v196, -v199, v199, v196
v_add_f32 v197, v197, v197
v_mul_f32 v21, v196, v196
v_mul_f32 v22, v196, v197
s_waitcnt lgkmcnt(0)
s_waitcnt vmcnt(8)
s_barrier
v_mfma_f32_32x32x16_bf16 v[64:79], v[48:51], v[56:59], v[64:79]
ds_read_b128 v[32:35], v2 offset:32768
ds_read_b128 v[40:43], v6 offset:32768
v_mfma_f32_32x32x16_bf16 v[80:95], v[48:51], v[60:63], v[80:95]
ds_read_b128 v[44:47], v6 offset:36864
ds_read_b128 v[36:39], v2 offset:36864
v_mfma_f32_32x32x16_bf16 v[96:111], v[52:55], v[56:59], v[96:111]
s_add_u32 m0, s56, 16384
s_add_u32 s67, s54, s53
buffer_load_dwordx4 v10, s[40:43], s67 offen offset:0 lds
buffer_load_dwordx4 v11, s[40:43], s67 offen offset:1024 lds
v_mfma_f32_32x32x16_bf16 v[112:127], v[52:55], v[60:63], v[112:127]
v_fma_f32 v21, -v197, v197, v21
v_add_f32 v22, v22, v22
v_mul_f32 v23, v21, v21
v_mul_f32 v24, v21, v22
v_fma_f32 v23, -v22, v22, v23
v_add_f32 v24, v24, v24
v_mul_f32 v196, v23, v23
v_mul_f32 v197, v23, v24
s_waitcnt lgkmcnt(0)
v_mfma_f32_32x32x16_bf16 v[64:79], v[32:35], v[40:43], v[64:79]
ds_read_b128 v[48:51], v3 offset:32768
ds_read_b128 v[56:59], v7 offset:32768
v_mfma_f32_32x32x16_bf16 v[80:95], v[32:35], v[44:47], v[80:95]
ds_read_b128 v[60:63], v7 offset:36864
ds_read_b128 v[52:55], v3 offset:36864
v_mfma_f32_32x32x16_bf16 v[96:111], v[36:39], v[40:43], v[96:111]
buffer_load_dwordx4 v12, s[40:43], s67 offen offset:2048 lds
buffer_load_dwordx4 v13, s[40:43], s67 offen offset:3072 lds
v_mfma_f32_32x32x16_bf16 v[112:127], v[36:39], v[44:47], v[112:127]
v_fma_f32 v196, -v24, v24, v196
v_add_f32 v197, v197, v197
v_mul_f32 v25, v196, v196
v_mul_f32 v26, v196, v197
v_fma_f32 v25, -v197, v197, v25
v_add_f32 v26, v26, v26
v_mul_f32 v198, v196, v23
v_mul_f32 v199, v196, v24
s_waitcnt lgkmcnt(0)
v_mfma_f32_32x32x16_bf16 v[64:79], v[48:51], v[56:59], v[64:79]
ds_read_b128 v[32:35], v4 offset:32768
ds_read_b128 v[40:43], v8 offset:32768
v_mfma_f32_32x32x16_bf16 v[80:95], v[48:51], v[60:63], v[80:95]
ds_read_b128 v[44:47], v8 offset:36864
ds_read_b128 v[36:39], v4 offset:36864
v_mfma_f32_32x32x16_bf16 v[96:111], v[52:55], v[56:59], v[96:111]
s_add_u32 m0, s56, 65536
s_add_u32 s67, s55, s53
buffer_load_dwordx4 v14, s[44:47], s67 offen offset:0 lds
buffer_load_dwordx4 v15, s[44:47], s67 offen offset:1024 lds
v_mfma_f32_32x32x16_bf16 v[112:127], v[52:55], v[60:63], v[112:127]
v_fma_f32 v198, -v197, v24, v198
v_fmac_f32 v199, v197, v23
s_cmp_eq_u32 s57, 0
s_cselect_b64 s[60:61], 0, -1
v_cndmask_b32 v200, 1.0, v196, s[60:61]
v_cndmask_b32 v201, 0, v197, s[60:61]
s_waitcnt lgkmcnt(0)
v_mfma_f32_32x32x16_bf16 v[64:79], v[32:35], v[40:43], v[64:79]
ds_read_b128 v[48:51], v5 offset:32768
ds_read_b128 v[56:59], v9 offset:32768
v_mfma_f32_32x32x16_bf16 v[80:95], v[32:35], v[44:47], v[80:95]
ds_read_b128 v[60:63], v9 offset:36864
ds_read_b128 v[52:55], v5 offset:36864
v_mfma_f32_32x32x16_bf16 v[96:111], v[36:39], v[40:43], v[96:111]
buffer_load_dwordx4 v16, s[44:47], s67 offen offset:2048 lds
buffer_load_dwordx4 v17, s[44:47], s67 offen offset:3072 lds
s_add_u32 s53, s53, 128
s_cmp_ge_u32 s53, 896
s_cselect_b32 s60, 896, 0
s_sub_u32 s53, s53, s60
v_mfma_f32_32x32x16_bf16 v[112:127], v[36:39], v[44:47], v[112:127]
v_cndmask_b32 v202, v23, v198, s[60:61]
v_cndmask_b32 v203, v24, v199, s[60:61]
v_cmp_lt_u32 vcc, 31, v1
s_nop 1
v_cndmask_b32 v27, v200, v202, vcc
v_cndmask_b32 v28, v201, v203, vcc
s_waitcnt lgkmcnt(0)
s_waitcnt vmcnt(8)
s_barrier
v_mfma_f32_32x32x16_bf16 v[64:79], v[48:51], v[56:59], v[64:79]
ds_read_b128 v[32:35], v2 offset:0
ds_read_b128 v[40:43], v6 offset:0
v_mfma_f32_32x32x16_bf16 v[80:95], v[48:51], v[60:63], v[80:95]
ds_read_b128 v[44:47], v6 offset:4096
ds_read_b128 v[36:39], v2 offset:4096
v_mfma_f32_32x32x16_bf16 v[96:111], v[52:55], v[56:59], v[96:111]
s_add_u32 m0, s56, 32768
s_add_u32 s67, s54, s53
buffer_load_dwordx4 v10, s[40:43], s67 offen offset:0 lds
v_mfma_f32_32x32x16_bf16 v[112:127], v[52:55], v[60:63], v[112:127]
buffer_load_dwordx4 v11, s[40:43], s67 offen offset:1024 lds
s_waitcnt lgkmcnt(0)
v_mfma_f32_32x32x16_bf16 v[64:79], v[32:35], v[40:43], v[64:79]
ds_read_b128 v[48:51], v3 offset:0
ds_read_b128 v[56:59], v7 offset:0
v_mfma_f32_32x32x16_bf16 v[80:95], v[32:35], v[44:47], v[80:95]
ds_read_b128 v[60:63], v7 offset:4096
ds_read_b128 v[52:55], v3 offset:4096
v_mfma_f32_32x32x16_bf16 v[96:111], v[36:39], v[40:43], v[96:111]
buffer_load_dwordx4 v12, s[40:43], s67 offen offset:2048 lds
v_mfma_f32_32x32x16_bf16 v[112:127], v[36:39], v[44:47], v[112:127]
buffer_load_dwordx4 v13, s[40:43], s67 offen offset:3072 lds
s_waitcnt lgkmcnt(0)
v_mfma_f32_32x32x16_bf16 v[64:79], v[48:51], v[56:59], v[64:79]
ds_read_b128 v[32:35], v4 offset:0
ds_read_b128 v[40:43], v8 offset:0
v_mfma_f32_32x32x16_bf16 v[80:95], v[48:51], v[60:63], v[80:95]
ds_read_b128 v[44:47], v8 offset:4096
ds_read_b128 v[36:39], v4 offset:4096
v_mfma_f32_32x32x16_bf16 v[96:111], v[52:55], v[56:59], v[96:111]
s_add_u32 m0, s56, 81920
s_add_u32 s67, s55, s53
buffer_load_dwordx4 v14, s[44:47], s67 offen offset:0 lds
buffer_load_dwordx4 v15, s[44:47], s67 offen offset:1024 lds
v_mfma_f32_32x32x16_bf16 v[112:127], v[52:55], v[60:63], v[112:127]
v_mov_b32 v128, 0
v_mov_b32 v129, s52
v_mov_b32 v130, 0
v_mov_b32 v131, s52
s_waitcnt lgkmcnt(0)
v_mfma_f32_32x32x16_bf16 v[64:79], v[32:35], v[40:43], v[64:79]
ds_read_b128 v[48:51], v5 offset:0
ds_read_b128 v[56:59], v9 offset:0
v_mfma_f32_32x32x16_bf16 v[80:95], v[32:35], v[44:47], v[80:95]
ds_read_b128 v[60:63], v9 offset:4096
ds_read_b128 v[52:55], v5 offset:4096
v_mfma_f32_32x32x16_bf16 v[96:111], v[36:39], v[40:43], v[96:111]
buffer_load_dwordx4 v16, s[44:47], s67 offen offset:2048 lds
buffer_load_dwordx4 v17, s[44:47], s67 offen offset:3072 lds
s_add_u32 s53, s53, 128
s_cmp_ge_u32 s53, 896
s_cselect_b32 s60, 896, 0
s_sub_u32 s53, s53, s60
v_mfma_f32_32x32x16_bf16 v[112:127], v[36:39], v[44:47], v[112:127]
v_mov_b32 v132, 0
v_mov_b32 v133, s52
v_mov_b32 v134, 0
v_mov_b32 v135, s52
s_waitcnt lgkmcnt(0)
s_waitcnt vmcnt(8)
s_barrier
v_mfma_f32_32x32x16_bf16 v[64:79], v[48:51], v[56:59], v[64:79]
ds_read_b128 v[32:35], v2 offset:16384
ds_read_b128 v[40:43], v6 offset:16384
v_mfma_f32_32x32x16_bf16 v[80:95], v[48:51], v[60:63], v[80:95]
ds_read_b128 v[44:47], v6 offset:20480
ds_read_b128 v[36:39], v2 offset:20480
v_mfma_f32_32x32x16_bf16 v[96:111], v[52:55], v[56:59], v[96:111]
s_add_u32 m0, s56, 0
s_add_u32 s67, s54, s53
buffer_load_dwordx4 v10, s[40:43], s67 offen offset:0 lds
buffer_load_dwordx4 v11, s[40:43], s67 offen offset:1024 lds
v_mfma_f32_32x32x16_bf16 v[112:127], v[52:55], v[60:63], v[112:127]
v_mov_b32 v136, 0
v_mov_b32 v137, s52
v_mov_b32 v138, 0
v_mov_b32 v139, s52
s_waitcnt lgkmcnt(0)
v_mfma_f32_32x32x16_bf16 v[64:79], v[32:35], v[40:43], v[64:79]
ds_read_b128 v[48:51], v3 offset:16384
ds_read_b128 v[56:59], v7 offset:16384
v_mfma_f32_32x32x16_bf16 v[80:95], v[32:35], v[44:47], v[80:95]
ds_read_b128 v[60:63], v7 offset:20480
ds_read_b128 v[52:55], v3 offset:20480
v_mfma_f32_32x32x16_bf16 v[96:111], v[36:39], v[40:43], v[96:111]
buffer_load_dwordx4 v12, s[40:43], s67 offen offset:2048 lds
buffer_load_dwordx4 v13, s[40:43], s67 offen offset:3072 lds
v_mfma_f32_32x32x16_bf16 v[112:127], v[36:39], v[44:47], v[112:127]
v_mov_b32 v140, 0
v_mov_b32 v141, s52
v_mov_b32 v142, 0
v_mov_b32 v143, s52
s_waitcnt lgkmcnt(0)
v_mfma_f32_32x32x16_bf16 v[64:79], v[48:51], v[56:59], v[64:79]
ds_read_b128 v[32:35], v4 offset:16384
ds_read_b128 v[40:43], v8 offset:16384
v_mfma_f32_32x32x16_bf16 v[80:95], v[48:51], v[60:63], v[80:95]
ds_read_b128 v[44:47], v8 offset:20480
ds_read_b128 v[36:39], v4 offset:20480
v_mfma_f32_32x32x16_bf16 v[96:111], v[52:55], v[56:59], v[96:111]
s_add_u32 m0, s56, 49152
s_add_u32 s67, s55, s53
buffer_load_dwordx4 v14, s[44:47], s67 offen offset:0 lds
buffer_load_dwordx4 v15, s[44:47], s67 offen offset:1024 lds
v_mfma_f32_32x32x16_bf16 v[112:127], v[52:55], v[60:63], v[112:127]
v_mov_b32 v144, 0
v_mov_b32 v145, s52
v_mov_b32 v146, 0
v_mov_b32 v147, s52
s_waitcnt lgkmcnt(0)
v_mfma_f32_32x32x16_bf16 v[64:79], v[32:35], v[40:43], v[64:79]
ds_read_b128 v[48:51], v5 offset:16384
ds_read_b128 v[56:59], v9 offset:16384
v_mfma_f32_32x32x16_bf16 v[80:95], v[32:35], v[44:47], v[80:95]
ds_read_b128 v[60:63], v9 offset:20480
ds_read_b128 v[52:55], v5 offset:20480
v_mfma_f32_32x32x16_bf16 v[96:111], v[36:39], v[40:43], v[96:111]
buffer_load_dwordx4 v16, s[44:47], s67 offen offset:2048 lds
buffer_load_dwordx4 v17, s[44:47], s67 offen offset:3072 lds
s_add_u32 s53, s53, 128
s_cmp_ge_u32 s53, 896
s_cselect_b32 s60, 896, 0
s_sub_u32 s53, s53, s60
v_mfma_f32_32x32x16_bf16 v[112:127], v[36:39], v[44:47], v[112:127]
v_mov_b32 v148, 0
v_mov_b32 v149, s52
v_mov_b32 v150, 0
v_mov_b32 v151, s52
s_waitcnt lgkmcnt(0)
s_waitcnt vmcnt(8)
s_barrier
v_mfma_f32_32x32x16_bf16 v[64:79], v[48:51], v[56:59], v[64:79]
ds_read_b128 v[32:35], v2 offset:32768
ds_read_b128 v[40:43], v6 offset:32768
v_mfma_f32_32x32x16_bf16 v[80:95], v[48:51], v[60:63], v[80:95]
ds_read_b128 v[44:47], v6 offset:36864
ds_read_b128 v[36:39], v2 offset:36864
v_mfma_f32_32x32x16_bf16 v[96:111], v[52:55], v[56:59], v[96:111]
buffer_load_dword v254, v253, s[36:39], 0 offen
v_mfma_f32_32x32x16_bf16 v[112:127], v[52:55], v[60:63], v[112:127]
v_mov_b32 v152, 0
v_mov_b32 v153, s52
v_mov_b32 v154, 0
v_mov_b32 v155, s52
s_waitcnt lgkmcnt(0)
v_mfma_f32_32x32x16_bf16 v[64:79], v[32:35], v[40:43], v[64:79]
ds_read_b128 v[48:51], v3 offset:32768
ds_read_b128 v[56:59], v7 offset:32768
v_mfma_f32_32x32x16_bf16 v[80:95], v[32:35], v[44:47], v[80:95]
ds_read_b128 v[60:63], v7 offset:36864
ds_read_b128 v[52:55], v3 offset:36864
v_mfma_f32_32x32x16_bf16 v[96:111], v[36:39], v[40:43], v[96:111]
v_mov_b32 v156, 0
v_mov_b32 v157, s52
v_mov_b32 v158, 0
v_mov_b32 v159, s52
v_and_b32 v196, 7, v1
v_lshrrev_b32 v197, 4, v1
v_xor_b32 v198, v196, v197
v_lshlrev_b32 v198, 4, v198
v_mfma_f32_32x32x16_bf16 v[112:127], v[36:39], v[44:47], v[112:127]
v_xor_b32 v199, 64, v198
v_lshrrev_b32 v196, 3, v1
s_lshl_b32 s59, s58, 5
v_add_u32 v197, s59, v196
s_waitcnt lgkmcnt(0)
v_mfma_f32_32x32x16_bf16 v[64:79], v[48:51], v[56:59], v[64:79]
ds_read_b128 v[32:35], v4 offset:32768
ds_read_b128 v[40:43], v8 offset:32768
v_mfma_f32_32x32x16_bf16 v[80:95], v[48:51], v[60:63], v[80:95]
ds_read_b128 v[44:47], v8 offset:36864
ds_read_b128 v[36:39], v4 offset:36864
v_mfma_f32_32x32x16_bf16 v[96:111], v[52:55], v[56:59], v[96:111]
v_mul_u32_u24 v197, 896, v197
v_add_u32 v14, v197, v198
v_add_u32 v15, v197, v199
v_add_u32 v15, 6144, v15
v_mfma_f32_32x32x16_bf16 v[112:127], v[52:55], v[60:63], v[112:127]
v_add_u32 v16, v197, v198
v_add_u32 v16, 12288, v16
v_add_u32 v17, v197, v199
v_add_u32 v17, 18432, v17
s_waitcnt lgkmcnt(0)
v_mfma_f32_32x32x16_bf16 v[64:79], v[32:35], v[40:43], v[64:79]
ds_read_b128 v[48:51], v5 offset:32768
ds_read_b128 v[56:59], v9 offset:32768
v_mfma_f32_32x32x16_bf16 v[80:95], v[32:35], v[44:47], v[80:95]
ds_read_b128 v[60:63], v9 offset:36864
ds_read_b128 v[52:55], v5 offset:36864
v_mfma_f32_32x32x16_bf16 v[96:111], v[36:39], v[40:43], v[96:111]
s_lshl_b32 s59, s4, 5
v_add_u32 v196, s59, v196
v_mul_u32_u24 v196, 896, v196
v_add_u32 v10, v196, v198
v_mfma_f32_32x32x16_bf16 v[112:127], v[36:39], v[44:47], v[112:127]
v_add_u32 v11, v196, v199
v_add_u32 v11, 6144, v11
v_add_u32 v12, v196, v198
v_add_u32 v12, 12288, v12
s_waitcnt lgkmcnt(0)
s_waitcnt vmcnt(1)
s_barrier
v_mfma_f32_32x32x16_bf16 v[64:79], v[48:51], v[56:59], v[64:79]
ds_read_b128 v[32:35], v2 offset:0
ds_read_b128 v[40:43], v6 offset:0
v_mfma_f32_32x32x16_bf16 v[80:95], v[48:51], v[60:63], v[80:95]
ds_read_b128 v[44:47], v6 offset:4096
ds_read_b128 v[36:39], v2 offset:4096
v_mfma_f32_32x32x16_bf16 v[96:111], v[52:55], v[56:59], v[96:111]
v_add_u32 v13, v196, v199
v_add_u32 v13, 18432, v13
s_mul_i32 s75, s6, 57344
v_mfma_f32_32x32x16_bf16 v[112:127], v[52:55], v[60:63], v[112:127]
s_waitcnt lgkmcnt(0)
v_mfma_f32_32x32x16_bf16 v[64:79], v[32:35], v[40:43], v[64:79]
ds_read_b128 v[48:51], v3 offset:0
ds_read_b128 v[56:59], v7 offset:0
v_mfma_f32_32x32x16_bf16 v[80:95], v[32:35], v[44:47], v[80:95]
ds_read_b128 v[60:63], v7 offset:4096
ds_read_b128 v[52:55], v3 offset:4096
v_mfma_f32_32x32x16_bf16 v[96:111], v[36:39], v[40:43], v[96:111]
v_mfma_f32_32x32x16_bf16 v[112:127], v[36:39], v[44:47], v[112:127]
s_waitcnt lgkmcnt(0)
v_mfma_f32_32x32x16_bf16 v[64:79], v[48:51], v[56:59], v[64:79]
ds_read_b128 v[32:35], v4 offset:0
ds_read_b128 v[40:43], v8 offset:0
v_mfma_f32_32x32x16_bf16 v[80:95], v[48:51], v[60:63], v[80:95]
ds_read_b128 v[44:47], v8 offset:4096
ds_read_b128 v[36:39], v4 offset:4096
v_mfma_f32_32x32x16_bf16 v[96:111], v[52:55], v[56:59], v[96:111]
v_mfma_f32_32x32x16_bf16 v[112:127], v[52:55], v[60:63], v[112:127]
s_waitcnt lgkmcnt(0)
v_mfma_f32_32x32x16_bf16 v[64:79], v[32:35], v[40:43], v[64:79]
ds_read_b128 v[48:51], v5 offset:0
ds_read_b128 v[56:59], v9 offset:0
v_mfma_f32_32x32x16_bf16 v[80:95], v[32:35], v[44:47], v[80:95]
ds_read_b128 v[60:63], v9 offset:4096
ds_read_b128 v[52:55], v5 offset:4096
v_mfma_f32_32x32x16_bf16 v[96:111], v[36:39], v[40:43], v[96:111]
v_mfma_f32_32x32x16_bf16 v[112:127], v[36:39], v[44:47], v[112:127]
s_waitcnt lgkmcnt(0)
v_mfma_f32_32x32x16_bf16 v[64:79], v[48:51], v[56:59], v[64:79]
v_mfma_f32_32x32x16_bf16 v[80:95], v[48:51], v[60:63], v[80:95]
v_mfma_f32_32x32x16_bf16 v[96:111], v[52:55], v[56:59], v[96:111]
v_mfma_f32_32x32x16_bf16 v[112:127], v[52:55], v[60:63], v[112:127]
v_lshlrev_b32 v4, 4, v1
global_load_ushort v240, v192, s[24:25]
s_nop 7
s_nop 3
v_fma_f32 v244, v18, v64, v65
v_fma_f32 v248, v18, v96, v97
v_fma_f32 v245, v18, v80, v81
v_fma_f32 v249, v18, v112, v113
v_fmac_f32 v244, v20, v80
v_fmac_f32 v248, v20, v112
v_fmac_f32 v245, v19, v64
v_fmac_f32 v249, v19, v96
v_fma_f32 v242, v18, v244, v66
v_fma_f32 v246, v18, v248, v98
v_fma_f32 v243, v18, v245, v82
v_fma_f32 v247, v18, v249, v114
v_fmac_f32 v242, v20, v245
v_fmac_f32 v246, v20, v249
v_fmac_f32 v243, v19, v244
v_fmac_f32 v247, v19, v248
s_add_u32 m0, s56, 16384
s_add_u32 s67, s6, 1
s_cmp_ge_u32 s67, 7
s_cselect_b32 s60, 7, 0
s_sub_u32 s67, s67, s60
s_lshl_b32 s67, s67, 7
s_add_u32 s67, s67, s75
buffer_load_dwordx4 v14, s[36:39], s67 offen offset:0 lds
v_fma_f32 v244, v18, v242, v67
v_fma_f32 v248, v18, v246, v99
v_fma_f32 v245, v18, v243, v83
v_fma_f32 v249, v18, v247, v115
v_fmac_f32 v244, v20, v243
v_fmac_f32 v248, v20, v247
v_fmac_f32 v245, v19, v242
v_fmac_f32 v249, v19, v246
v_fma_f32 v242, v18, v244, v68
v_fma_f32 v246, v18, v248, v100
v_fma_f32 v243, v18, v245, v84
v_fma_f32 v247, v18, v249, v116
v_fmac_f32 v242, v20, v245
v_fmac_f32 v246, v20, v249
v_fmac_f32 v243, v19, v244
v_fmac_f32 v247, v19, v248
buffer_load_dwordx4 v15, s[36:39], s67 offen offset:1024 lds
v_fma_f32 v244, v18, v242, v69
v_fma_f32 v248, v18, v246, v101
v_fma_f32 v245, v18, v243, v85
v_fma_f32 v249, v18, v247, v117
v_fmac_f32 v244, v20, v243
v_fmac_f32 v248, v20, v247
v_fmac_f32 v245, v19, v242
v_fmac_f32 v249, v19, v246
buffer_load_dwordx4 v16, s[36:39], s67 offen offset:2048 lds
v_fma_f32 v242, v18, v244, v70
v_fma_f32 v246, v18, v248, v102
v_fma_f32 v243, v18, v245, v86
v_fma_f32 v247, v18, v249, v118
v_fmac_f32 v242, v20, v245
v_fmac_f32 v246, v20, v249
v_fmac_f32 v243, v19, v244
v_fmac_f32 v247, v19, v248
v_fma_f32 v244, v18, v242, v71
v_fma_f32 v248, v18, v246, v103
v_fma_f32 v245, v18, v243, v87
v_fma_f32 v249, v18, v247, v119
v_fmac_f32 v244, v20, v243
v_fmac_f32 v248, v20, v247
v_fmac_f32 v245, v19, v242
v_fmac_f32 v249, v19, v246
buffer_load_dwordx4 v17, s[36:39], s67 offen offset:3072 lds
v_fma_f32 v242, v18, v244, v72
v_fma_f32 v246, v18, v248, v104
v_fma_f32 v243, v18, v245, v88
v_fma_f32 v247, v18, v249, v120
v_fmac_f32 v242, v20, v245
v_fmac_f32 v246, v20, v249
v_fmac_f32 v243, v19, v244
v_fmac_f32 v247, v19, v248
v_fma_f32 v244, v18, v242, v73
v_fma_f32 v248, v18, v246, v105
v_fma_f32 v245, v18, v243, v89
v_fma_f32 v249, v18, v247, v121
v_fmac_f32 v244, v20, v243
v_fmac_f32 v248, v20, v247
v_fmac_f32 v245, v19, v242
v_fmac_f32 v249, v19, v246
s_add_u32 m0, s56, 32768
s_add_u32 s67, s6, 2
s_cmp_ge_u32 s67, 7
s_cselect_b32 s60, 7, 0
s_sub_u32 s67, s67, s60
s_lshl_b32 s67, s67, 7
s_add_u32 s67, s67, s75
buffer_load_dwordx4 v14, s[36:39], s67 offen offset:0 lds
v_fma_f32 v242, v18, v244, v74
v_fma_f32 v246, v18, v248, v106
v_fma_f32 v243, v18, v245, v90
v_fma_f32 v247, v18, v249, v122
v_fmac_f32 v242, v20, v245
v_fmac_f32 v246, v20, v249
v_fmac_f32 v243, v19, v244
v_fmac_f32 v247, v19, v248
buffer_load_dwordx4 v15, s[36:39], s67 offen offset:1024 lds
v_fma_f32 v244, v18, v242, v75
v_fma_f32 v248, v18, v246, v107
v_fma_f32 v245, v18, v243, v91
v_fma_f32 v249, v18, v247, v123
v_fmac_f32 v244, v20, v243
v_fmac_f32 v248, v20, v247
v_fmac_f32 v245, v19, v242
v_fmac_f32 v249, v19, v246
v_fma_f32 v242, v18, v244, v76
v_fma_f32 v246, v18, v248, v108
v_fma_f32 v243, v18, v245, v92
v_fma_f32 v247, v18, v249, v124
v_fmac_f32 v242, v20, v245
v_fmac_f32 v246, v20, v249
v_fmac_f32 v243, v19, v244
v_fmac_f32 v247, v19, v248
buffer_load_dwordx4 v16, s[36:39], s67 offen offset:2048 lds
v_fma_f32 v244, v18, v242, v77
v_fma_f32 v248, v18, v246, v109
v_fma_f32 v245, v18, v243, v93
v_fma_f32 v249, v18, v247, v125
v_fmac_f32 v244, v20, v243
v_fmac_f32 v248, v20, v247
v_fmac_f32 v245, v19, v242
v_fmac_f32 v249, v19, v246
v_fma_f32 v242, v18, v244, v78
v_fma_f32 v246, v18, v248, v110
v_fma_f32 v243, v18, v245, v94
v_fma_f32 v247, v18, v249, v126
v_fmac_f32 v242, v20, v245
v_fmac_f32 v246, v20, v249
v_fmac_f32 v243, v19, v244
v_fmac_f32 v247, v19, v248
buffer_load_dwordx4 v17, s[36:39], s67 offen offset:3072 lds
v_fma_f32 v244, v18, v242, v79
v_fma_f32 v248, v18, v246, v111
v_fma_f32 v245, v18, v243, v95
v_fma_f32 v249, v18, v247, v127
v_fmac_f32 v244, v20, v243
v_fmac_f32 v248, v20, v247
v_fmac_f32 v245, v19, v242
v_fmac_f32 v249, v19, v246
v_fma_f32 v200, v21, v244, v248
v_fma_f32 v201, v21, v245, v249
v_fma_f32 v200, -v22, v245, v200
v_fmac_f32 v201, v22, v244
v_lshrrev_b32 v202, 5, v1
s_lshl_b32 s59, s58, 2
s_lshl_b32 s60, s57, 1
s_add_u32 s59, s59, s60
v_add_u32 v202, s59, v202
v_lshlrev_b32 v202, 8, v202
v_lshl_add_u32 v202, v29, 3, v202
v_add_u32 v202, 131072, v202
ds_write_b64 v202, v[200:201]
s_lshl_b32 s59, s58, 10
s_add_u32 s59, s59, 131072
v_lshlrev_b32 v203, 3, v29
v_add_u32 v203, s59, v203
s_lshl_b32 s59, s58, 9
v_lshlrev_b32 v218, 4, v29
v_add_u32 v218, s59, v218
v_mov_b32 v221, s52
v_mov_b32 v223, s52
s_lshl_b32 s61, s6, 14
s_add_u32 s61, s61, 16384
s_lshl_b32 s62, s5, 10
s_add_u32 s62, s62, s61
s_waitcnt lgkmcnt(0)
s_barrier
ds_read_b64 v[204:205], v203 offset:0
ds_read_b64 v[206:207], v203 offset:256
ds_read_b64 v[208:209], v203 offset:512
ds_read_b64 v[210:211], v203 offset:768
s_waitcnt lgkmcnt(0)
v_fma_f32 v212, v23, v204, v206
v_fma_f32 v213, v23, v205, v207
v_fma_f32 v212, -v24, v205, v212
v_fmac_f32 v213, v24, v204
v_fma_f32 v214, v23, v212, v208
v_fma_f32 v215, v23, v213, v209
v_fma_f32 v214, -v24, v213, v214
v_fmac_f32 v215, v24, v212
v_fma_f32 v220, v23, v214, v210
v_fma_f32 v222, v23, v215, v211
v_fma_f32 v220, -v24, v215, v220
v_fmac_f32 v222, v24, v214
s_cmp_eq_u32 s57, 0
s_cbranch_scc0 L_nopub_30
s_mov_b32 exec_hi, 0
buffer_store_dwordx4 v[220:223], v218, s[48:51], s62 offen sc1
s_mov_b32 exec_hi, -1
L_nopub_30:
v_cmp_lt_u32 vcc, 31, v1
s_cmp_eq_u32 s57, 0
s_cbranch_scc0 L_cin_31
v_cndmask_b32 v224, 0, v204, vcc
v_cndmask_b32 v225, 0, v205, vcc
s_branch L_cind_32
L_cin_31:
v_cndmask_b32 v224, v212, v214, vcc
v_cndmask_b32 v225, v213, v215, vcc
L_cind_32:
v_lshrrev_b32 v219, 5, v1
v_lshlrev_b32 v219, 10, v219
v_sub_u32 v219, v218, v219
v_add_u32 v219, 16384, v219
s_sub_u32 s62, s62, 17408
v_pk_mul_f32 v[168:169], v[80:81], v[30:31] op_sel:[0,1] op_sel_hi:[1,1] neg_lo:[0,1] neg_hi:[0,1]
v_pk_mul_f32 v[80:81], v[80:81], v[30:31] op_sel_hi:[1,0]
v_pk_fma_f32 v[80:81], v[64:65], v[30:31], v[80:81] op_sel:[0,1,0] op_sel_hi:[1,1,1]
v_pk_fma_f32 v[64:65], v[64:65], v[30:31], v[168:169] op_sel_hi:[1,0,1]
v_pk_mul_f32 v[168:169], v[82:83], v[30:31] op_sel:[0,1] op_sel_hi:[1,1] neg_lo:[0,1] neg_hi:[0,1]
v_pk_mul_f32 v[82:83], v[82:83], v[30:31] op_sel_hi:[1,0]
v_pk_fma_f32 v[82:83], v[66:67], v[30:31], v[82:83] op_sel:[0,1,0] op_sel_hi:[1,1,1]
v_pk_fma_f32 v[66:67], v[66:67], v[30:31], v[168:169] op_sel_hi:[1,0,1]
s_add_u32 m0, s56, 0
s_add_u32 s67, s6, 0
s_cmp_ge_u32 s67, 7
s_cselect_b32 s60, 7, 0
s_sub_u32 s67, s67, s60
s_lshl_b32 s67, s67, 7
s_add_u32 s67, s67, s75
buffer_load_dwordx4 v14, s[36:39], s67 offen offset:0 lds
v_pk_mul_f32 v[168:169], v[84:85], v[30:31] op_sel:[0,1] op_sel_hi:[1,1] neg_lo:[0,1] neg_hi:[0,1]
v_pk_mul_f32 v[84:85], v[84:85], v[30:31] op_sel_hi:[1,0]
v_pk_fma_f32 v[84:85], v[68:69], v[30:31], v[84:85] op_sel:[0,1,0] op_sel_hi:[1,1,1]
v_pk_fma_f32 v[68:69], v[68:69], v[30:31], v[168:169] op_sel_hi:[1,0,1]
v_pk_mul_f32 v[168:169], v[86:87], v[30:31] op_sel:[0,1] op_sel_hi:[1,1] neg_lo:[0,1] neg_hi:[0,1]
v_pk_mul_f32 v[86:87], v[86:87], v[30:31] op_sel_hi:[1,0]
v_pk_fma_f32 v[86:87], v[70:71], v[30:31], v[86:87] op_sel:[0,1,0] op_sel_hi:[1,1,1]
v_pk_fma_f32 v[70:71], v[70:71], v[30:31], v[168:169] op_sel_hi:[1,0,1]
buffer_load_dwordx4 v15, s[36:39], s67 offen offset:1024 lds
v_pk_mul_f32 v[168:169], v[88:89], v[30:31] op_sel:[0,1] op_sel_hi:[1,1] neg_lo:[0,1] neg_hi:[0,1]
v_pk_mul_f32 v[88:89], v[88:89], v[30:31] op_sel_hi:[1,0]
v_pk_fma_f32 v[88:89], v[72:73], v[30:31], v[88:89] op_sel:[0,1,0] op_sel_hi:[1,1,1]
v_pk_fma_f32 v[72:73], v[72:73], v[30:31], v[168:169] op_sel_hi:[1,0,1]
v_pk_mul_f32 v[168:169], v[90:91], v[30:31] op_sel:[0,1] op_sel_hi:[1,1] neg_lo:[0,1] neg_hi:[0,1]
v_pk_mul_f32 v[90:91], v[90:91], v[30:31] op_sel_hi:[1,0]
v_pk_fma_f32 v[90:91], v[74:75], v[30:31], v[90:91] op_sel:[0,1,0] op_sel_hi:[1,1,1]
v_pk_fma_f32 v[74:75], v[74:75], v[30:31], v[168:169] op_sel_hi:[1,0,1]
buffer_load_dwordx4 v16, s[36:39], s67 offen offset:2048 lds
v_pk_mul_f32 v[168:169], v[92:93], v[30:31] op_sel:[0,1] op_sel_hi:[1,1] neg_lo:[0,1] neg_hi:[0,1]
v_pk_mul_f32 v[92:93], v[92:93], v[30:31] op_sel_hi:[1,0]
v_pk_fma_f32 v[92:93], v[76:77], v[30:31], v[92:93] op_sel:[0,1,0] op_sel_hi:[1,1,1]
v_pk_fma_f32 v[76:77], v[76:77], v[30:31], v[168:169] op_sel_hi:[1,0,1]
v_pk_mul_f32 v[168:169], v[94:95], v[30:31] op_sel:[0,1] op_sel_hi:[1,1] neg_lo:[0,1] neg_hi:[0,1]
v_pk_mul_f32 v[94:95], v[94:95], v[30:31] op_sel_hi:[1,0]
v_pk_fma_f32 v[94:95], v[78:79], v[30:31], v[94:95] op_sel:[0,1,0] op_sel_hi:[1,1,1]
v_pk_fma_f32 v[78:79], v[78:79], v[30:31], v[168:169] op_sel_hi:[1,0,1]
buffer_load_dwordx4 v17, s[36:39], s67 offen offset:3072 lds
v_pk_mul_f32 v[168:169], v[112:113], v[30:31] op_sel:[0,1] op_sel_hi:[1,1] neg_lo:[0,1] neg_hi:[0,1]
v_pk_mul_f32 v[112:113], v[112:113], v[30:31] op_sel_hi:[1,0]
v_pk_fma_f32 v[112:113], v[96:97], v[30:31], v[112:113] op_sel:[0,1,0] op_sel_hi:[1,1,1]
v_pk_fma_f32 v[96:97], v[96:97], v[30:31], v[168:169] op_sel_hi:[1,0,1]
s_add_u32 m0, s56, 49152
s_add_u32 s67, s6, 3
s_cmp_ge_u32 s67, 7
s_cselect_b32 s60, 7, 0
s_sub_u32 s67, s67, s60
s_lshl_b32 s67, s67, 7
s_add_u32 s67, s67, s75
buffer_load_dwordx4 v14, s[36:39], s67 offen offset:0 lds
v_pk_mul_f32 v[168:169], v[114:115], v[30:31] op_sel:[0,1] op_sel_hi:[1,1] neg_lo:[0,1] neg_hi:[0,1]
v_pk_mul_f32 v[114:115], v[114:115], v[30:31] op_sel_hi:[1,0]
v_pk_fma_f32 v[114:115], v[98:99], v[30:31], v[114:115] op_sel:[0,1,0] op_sel_hi:[1,1,1]
v_pk_fma_f32 v[98:99], v[98:99], v[30:31], v[168:169] op_sel_hi:[1,0,1]
v_pk_mul_f32 v[168:169], v[116:117], v[30:31] op_sel:[0,1] op_sel_hi:[1,1] neg_lo:[0,1] neg_hi:[0,1]
v_pk_mul_f32 v[116:117], v[116:117], v[30:31] op_sel_hi:[1,0]
v_pk_fma_f32 v[116:117], v[100:101], v[30:31], v[116:117] op_sel:[0,1,0] op_sel_hi:[1,1,1]
v_pk_fma_f32 v[100:101], v[100:101], v[30:31], v[168:169] op_sel_hi:[1,0,1]
buffer_load_dwordx4 v15, s[36:39], s67 offen offset:1024 lds
v_pk_mul_f32 v[168:169], v[118:119], v[30:31] op_sel:[0,1] op_sel_hi:[1,1] neg_lo:[0,1] neg_hi:[0,1]
v_pk_mul_f32 v[118:119], v[118:119], v[30:31] op_sel_hi:[1,0]
v_pk_fma_f32 v[118:119], v[102:103], v[30:31], v[118:119] op_sel:[0,1,0] op_sel_hi:[1,1,1]
v_pk_fma_f32 v[102:103], v[102:103], v[30:31], v[168:169] op_sel_hi:[1,0,1]
v_pk_mul_f32 v[168:169], v[120:121], v[30:31] op_sel:[0,1] op_sel_hi:[1,1] neg_lo:[0,1] neg_hi:[0,1]
v_pk_mul_f32 v[120:121], v[120:121], v[30:31] op_sel_hi:[1,0]
v_pk_fma_f32 v[120:121], v[104:105], v[30:31], v[120:121] op_sel:[0,1,0] op_sel_hi:[1,1,1]
v_pk_fma_f32 v[104:105], v[104:105], v[30:31], v[168:169] op_sel_hi:[1,0,1]
buffer_load_dwordx4 v16, s[36:39], s67 offen offset:2048 lds
v_pk_mul_f32 v[168:169], v[122:123], v[30:31] op_sel:[0,1] op_sel_hi:[1,1] neg_lo:[0,1] neg_hi:[0,1]
v_pk_mul_f32 v[122:123], v[122:123], v[30:31] op_sel_hi:[1,0]
v_pk_fma_f32 v[122:123], v[106:107], v[30:31], v[122:123] op_sel:[0,1,0] op_sel_hi:[1,1,1]
v_pk_fma_f32 v[106:107], v[106:107], v[30:31], v[168:169] op_sel_hi:[1,0,1]
v_pk_mul_f32 v[168:169], v[124:125], v[30:31] op_sel:[0,1] op_sel_hi:[1,1] neg_lo:[0,1] neg_hi:[0,1]
v_pk_mul_f32 v[124:125], v[124:125], v[30:31] op_sel_hi:[1,0]
v_pk_fma_f32 v[124:125], v[108:109], v[30:31], v[124:125] op_sel:[0,1,0] op_sel_hi:[1,1,1]
v_pk_fma_f32 v[108:109], v[108:109], v[30:31], v[168:169] op_sel_hi:[1,0,1]
buffer_load_dwordx4 v17, s[36:39], s67 offen offset:3072 lds
v_pk_mul_f32 v[168:169], v[126:127], v[30:31] op_sel:[0,1] op_sel_hi:[1,1] neg_lo:[0,1] neg_hi:[0,1]
v_pk_mul_f32 v[126:127], v[126:127], v[30:31] op_sel_hi:[1,0]
v_pk_fma_f32 v[126:127], v[110:111], v[30:31], v[126:127] op_sel:[0,1,0] op_sel_hi:[1,1,1]
v_pk_fma_f32 v[110:111], v[110:111], v[30:31], v[168:169] op_sel_hi:[1,0,1]
s_cmp_gt_u32 s5, 14
s_cbranch_scc0 L_sk_33
s_cmp_eq_u32 s5, 15
s_cselect_b32 exec_hi, 0, -1
s_sub_u32 s59, s62, 14336
buffer_load_dwordx4 v[156:159], v219, s[48:51], s59 offen sc1
s_mov_b32 exec_hi, -1
L_sk_33:
s_cmp_gt_u32 s5, 12
s_cbranch_scc0 L_sk_34
s_cmp_eq_u32 s5, 13
s_cselect_b32 exec_hi, 0, -1
s_sub_u32 s59, s62, 12288
buffer_load_dwordx4 v[152:155], v219, s[48:51], s59 offen sc1
s_mov_b32 exec_hi, -1
L_sk_34:
s_cmp_gt_u32 s5, 10
s_cbranch_scc0 L_sk_35
s_cmp_eq_u32 s5, 11
s_cselect_b32 exec_hi, 0, -1
s_sub_u32 s59, s62, 10240
buffer_load_dwordx4 v[148:151], v219, s[48:51], s59 offen sc1
s_mov_b32 exec_hi, -1
L_sk_35:
s_cmp_gt_u32 s5, 8
s_cbranch_scc0 L_sk_36
s_cmp_eq_u32 s5, 9
s_cselect_b32 exec_hi, 0, -1
s_sub_u32 s59, s62, 8192
buffer_load_dwordx4 v[144:147], v219, s[48:51], s59 offen sc1
s_mov_b32 exec_hi, -1
L_sk_36:
s_cmp_gt_u32 s5, 6
s_cbranch_scc0 L_sk_37
s_cmp_eq_u32 s5, 7
s_cselect_b32 exec_hi, 0, -1
s_sub_u32 s59, s62, 6144
buffer_load_dwordx4 v[140:143], v219, s[48:51], s59 offen sc1
s_mov_b32 exec_hi, -1
L_sk_37:
s_cmp_gt_u32 s5, 4
s_cbranch_scc0 L_sk_38
s_cmp_eq_u32 s5, 5
s_cselect_b32 exec_hi, 0, -1
s_sub_u32 s59, s62, 4096
buffer_load_dwordx4 v[136:139], v219, s[48:51], s59 offen sc1
s_mov_b32 exec_hi, -1
L_sk_38:
s_cmp_gt_u32 s5, 2
s_cbranch_scc0 L_sk_39
s_cmp_eq_u32 s5, 3
s_cselect_b32 exec_hi, 0, -1
s_sub_u32 s59, s62, 2048
buffer_load_dwordx4 v[132:135], v219, s[48:51], s59 offen sc1
s_mov_b32 exec_hi, -1
L_sk_39:
s_cmp_gt_u32 s5, 0
s_cbranch_scc0 L_sk_40
s_cmp_eq_u32 s5, 1
s_cselect_b32 exec_hi, 0, -1
s_sub_u32 s59, s62, 0
buffer_load_dwordx4 v[128:131], v219, s[48:51], s59 offen sc1
s_mov_b32 exec_hi, -1
L_sk_40:
v_mul_f32 v226, v25, v25
v_mul_f32 v227, v25, v26
v_fma_f32 v226, -v26, v26, v226
v_add_f32 v227, v227, v227
v_mov_b32 v228, 0
v_mov_b32 v229, 0
v_mov_b32 v230, 0
v_mov_b32 v231, 0
s_mov_b32 s63, 0
s_waitcnt vmcnt(0)
s_cmp_eq_u32 s5, 0
s_cbranch_scc1 L_polldone_42
s_branch L_pollchk_43
L_poll_41:
s_sub_u32 s59, s5, 1
v_min_u32 v241, s59, v1
v_lshlrev_b32 v241, 10, v241
s_lshl_b32 s59, s58, 9
s_add_u32 s59, s59, s61
s_add_u32 s59, s59, 12
L_cp_44:
buffer_load_dword v239, v241, s[48:51], s59 offen sc1
s_add_u32 s63, s63, 1
s_waitcnt vmcnt(0)
v_cmp_ne_u32 vcc, s52, v239
s_cmp_lt_u32 s63, 1048576
s_cbranch_scc0 L_cpd_45
s_cbranch_vccnz L_cp_44
L_cpd_45:
s_cmp_gt_u32 s5, 14
s_cbranch_scc0 L_sk_46
s_cmp_eq_u32 s5, 15
s_cselect_b32 exec_hi, 0, -1
s_sub_u32 s59, s62, 14336
buffer_load_dwordx4 v[156:159], v219, s[48:51], s59 offen sc1
s_mov_b32 exec_hi, -1
L_sk_46:
s_cmp_gt_u32 s5, 12
s_cbranch_scc0 L_sk_47
s_cmp_eq_u32 s5, 13
s_cselect_b32 exec_hi, 0, -1
s_sub_u32 s59, s62, 12288
buffer_load_dwordx4 v[152:155], v219, s[48:51], s59 offen sc1
s_mov_b32 exec_hi, -1
L_sk_47:
s_cmp_gt_u32 s5, 10
s_cbranch_scc0 L_sk_48
s_cmp_eq_u32 s5, 11
s_cselect_b32 exec_hi, 0, -1
s_sub_u32 s59, s62, 10240
buffer_load_dwordx4 v[148:151], v219, s[48:51], s59 offen sc1
s_mov_b32 exec_hi, -1
L_sk_48:
s_cmp_gt_u32 s5, 8
s_cbranch_scc0 L_sk_49
s_cmp_eq_u32 s5, 9
s_cselect_b32 exec_hi, 0, -1
s_sub_u32 s59, s62, 8192
buffer_load_dwordx4 v[144:147], v219, s[48:51], s59 offen sc1
s_mov_b32 exec_hi, -1
L_sk_49:
s_cmp_gt_u32 s5, 6
s_cbranch_scc0 L_sk_50
s_cmp_eq_u32 s5, 7
s_cselect_b32 exec_hi, 0, -1
s_sub_u32 s59, s62, 6144
buffer_load_dwordx4 v[140:143], v219, s[48:51], s59 offen sc1
s_mov_b32 exec_hi, -1
L_sk_50:
s_cmp_gt_u32 s5, 4
s_cbranch_scc0 L_sk_51
s_cmp_eq_u32 s5, 5
s_cselect_b32 exec_hi, 0, -1
s_sub_u32 s59, s62, 4096
buffer_load_dwordx4 v[136:139], v219, s[48:51], s59 offen sc1
s_mov_b32 exec_hi, -1
L_sk_51:
s_cmp_gt_u32 s5, 2
s_cbranch_scc0 L_sk_52
s_cmp_eq_u32 s5, 3
s_cselect_b32 exec_hi, 0, -1
s_sub_u32 s59, s62, 2048
buffer_load_dwordx4 v[132:135], v219, s[48:51], s59 offen sc1
s_mov_b32 exec_hi, -1
L_sk_52:
s_cmp_gt_u32 s5, 0
s_cbranch_scc0 L_sk_53
s_cmp_eq_u32 s5, 1
s_cselect_b32 exec_hi, 0, -1
s_sub_u32 s59, s62, 0
buffer_load_dwordx4 v[128:131], v219, s[48:51], s59 offen sc1
s_mov_b32 exec_hi, -1
L_sk_53:
s_waitcnt vmcnt(0)
L_pollchk_43:
v_mov_b32 v232, s52
v_mov_b32 v233, s52
v_min3_u32 v232, v232, v129, v131
v_max3_u32 v233, v233, v129, v131
v_min3_u32 v232, v232, v133, v135
v_max3_u32 v233, v233, v133, v135
v_min3_u32 v232, v232, v137, v139
v_max3_u32 v233, v233, v137, v139
v_min3_u32 v232, v232, v141, v143
v_max3_u32 v233, v233, v141, v143
v_min3_u32 v232, v232, v145, v147
v_max3_u32 v233, v233, v145, v147
v_min3_u32 v232, v232, v149, v151
v_max3_u32 v233, v233, v149, v151
v_min3_u32 v232, v232, v153, v155
v_max3_u32 v233, v233, v153, v155
v_min3_u32 v232, v232, v157, v159
v_max3_u32 v233, v233, v157, v159
v_cmp_ne_u32 vcc, v232, v233
s_add_u32 s63, s63, 1
s_cmp_lt_u32 s63, 1048576
s_cbranch_scc0 L_A_horner
s_cbranch_vccnz L_poll_41
L_A_horner:
v_fma_f32 v230, v226, v156, v152
v_fma_f32 v231, v226, v158, v154
v_fma_f32 v230, -v227, v158, v230
v_fmac_f32 v231, v227, v156
v_fma_f32 v228, v226, v230, v148
v_fma_f32 v229, v226, v231, v150
v_fma_f32 v228, -v227, v231, v228
v_fmac_f32 v229, v227, v230
v_fma_f32 v230, v226, v228, v144
v_fma_f32 v231, v226, v229, v146
v_fma_f32 v230, -v227, v229, v230
v_fmac_f32 v231, v227, v228
v_fma_f32 v228, v226, v230, v140
v_fma_f32 v229, v226, v231, v142
v_fma_f32 v228, -v227, v231, v228
v_fmac_f32 v229, v227, v230
v_fma_f32 v230, v226, v228, v136
v_fma_f32 v231, v226, v229, v138
v_fma_f32 v230, -v227, v229, v230
v_fmac_f32 v231, v227, v228
v_fma_f32 v228, v226, v230, v132
v_fma_f32 v229, v226, v231, v134
v_fma_f32 v228, -v227, v231, v228
v_fmac_f32 v229, v227, v230
v_fma_f32 v230, v226, v228, v128
v_fma_f32 v231, v226, v229, v130
v_fma_f32 v230, -v227, v229, v230
v_fmac_f32 v231, v227, v228
v_mov_b32 v234, v230
v_mov_b32 v235, v230
v_mov_b32 v236, v231
v_mov_b32 v237, v231
s_nop 1
v_permlane32_swap_b32 v234, v235
v_permlane32_swap_b32 v236, v237
s_nop 1
v_fma_f32 v230, v25, v235, v234
v_fma_f32 v231, v25, v237, v236
v_fma_f32 v230, -v26, v237, v230
v_fmac_f32 v231, v26, v235
L_polldone_42:
v_fma_f32 v234, v27, v230, v224
v_fma_f32 v235, v27, v231, v225
v_fma_f32 v234, -v28, v231, v234
v_fmac_f32 v235, v28, v230
v_fma_f32 v236, v21, v234, v244
v_fma_f32 v237, v21, v235, v245
v_fma_f32 v236, -v22, v235, v236
v_fmac_f32 v237, v22, v234
v_mul_f32 v226, v30, v234
v_mul_f32 v227, v30, v235
v_fma_f32 v226, -v31, v235, v226
v_fmac_f32 v227, v31, v234
v_mul_f32 v228, v30, v236
v_mul_f32 v229, v30, v237
v_fma_f32 v228, -v31, v237, v228
v_fmac_f32 v229, v31, v236
v_fmac_f32 v64, v18, v226
v_fmac_f32 v96, v18, v228
v_fmac_f32 v80, v18, v227
v_fmac_f32 v112, v18, v229
v_fmac_f32 v64, v20, v227
v_fmac_f32 v96, v20, v229
v_fmac_f32 v80, v19, v226
v_fmac_f32 v112, v19, v228
v_fmac_f32 v65, v18, v64
v_fmac_f32 v97, v18, v96
v_fmac_f32 v81, v18, v80
v_fmac_f32 v113, v18, v112
v_fmac_f32 v65, v20, v80
v_fmac_f32 v97, v20, v112
v_fmac_f32 v81, v19, v64
v_fmac_f32 v113, v19, v96
s_add_u32 m0, s56, 65536
s_add_u32 s67, s6, 4
s_cmp_ge_u32 s67, 7
s_cselect_b32 s60, 7, 0
s_sub_u32 s67, s67, s60
s_lshl_b32 s67, s67, 7
s_add_u32 s67, s67, s75
buffer_load_dwordx4 v14, s[36:39], s67 offen offset:0 lds
v_fmac_f32 v66, v18, v65
v_fmac_f32 v98, v18, v97
v_fmac_f32 v82, v18, v81
v_fmac_f32 v114, v18, v113
v_fmac_f32 v66, v20, v81
v_fmac_f32 v98, v20, v113
v_fmac_f32 v82, v19, v65
v_fmac_f32 v114, v19, v97
v_fmac_f32 v67, v18, v66
v_fmac_f32 v99, v18, v98
v_fmac_f32 v83, v18, v82
v_fmac_f32 v115, v18, v114
v_fmac_f32 v67, v20, v82
v_fmac_f32 v99, v20, v114
v_fmac_f32 v83, v19, v66
v_fmac_f32 v115, v19, v98
buffer_load_dwordx4 v15, s[36:39], s67 offen offset:1024 lds
v_fmac_f32 v68, v18, v67
v_fmac_f32 v100, v18, v99
v_fmac_f32 v84, v18, v83
v_fmac_f32 v116, v18, v115
v_fmac_f32 v68, v20, v83
v_fmac_f32 v100, v20, v115
v_fmac_f32 v84, v19, v67
v_fmac_f32 v116, v19, v99
v_fmac_f32 v69, v18, v68
v_fmac_f32 v101, v18, v100
v_fmac_f32 v85, v18, v84
v_fmac_f32 v117, v18, v116
v_fmac_f32 v69, v20, v84
v_fmac_f32 v101, v20, v116
v_fmac_f32 v85, v19, v68
v_fmac_f32 v117, v19, v100
buffer_load_dwordx4 v16, s[36:39], s67 offen offset:2048 lds
v_fmac_f32 v70, v18, v69
v_fmac_f32 v102, v18, v101
v_fmac_f32 v86, v18, v85
v_fmac_f32 v118, v18, v117
v_fmac_f32 v70, v20, v85
v_fmac_f32 v102, v20, v117
v_fmac_f32 v86, v19, v69
v_fmac_f32 v118, v19, v101
v_fmac_f32 v71, v18, v70
v_fmac_f32 v103, v18, v102
v_fmac_f32 v87, v18, v86
v_fmac_f32 v119, v18, v118
v_fmac_f32 v71, v20, v86
v_fmac_f32 v103, v20, v118
v_fmac_f32 v87, v19, v70
v_fmac_f32 v119, v19, v102
buffer_load_dwordx4 v17, s[36:39], s67 offen offset:3072 lds
v_fmac_f32 v72, v18, v71
v_fmac_f32 v104, v18, v103
v_fmac_f32 v88, v18, v87
v_fmac_f32 v120, v18, v119
v_fmac_f32 v72, v20, v87
v_fmac_f32 v104, v20, v119
v_fmac_f32 v88, v19, v71
v_fmac_f32 v120, v19, v103
s_add_u32 m0, s56, 81920
s_add_u32 s67, s6, 5
s_cmp_ge_u32 s67, 7
s_cselect_b32 s60, 7, 0
s_sub_u32 s67, s67, s60
s_lshl_b32 s67, s67, 7
s_add_u32 s67, s67, s75
buffer_load_dwordx4 v14, s[36:39], s67 offen offset:0 lds
v_fmac_f32 v73, v18, v72
v_fmac_f32 v105, v18, v104
v_fmac_f32 v89, v18, v88
v_fmac_f32 v121, v18, v120
v_fmac_f32 v73, v20, v88
v_fmac_f32 v105, v20, v120
v_fmac_f32 v89, v19, v72
v_fmac_f32 v121, v19, v104
v_fmac_f32 v74, v18, v73
v_fmac_f32 v106, v18, v105
v_fmac_f32 v90, v18, v89
v_fmac_f32 v122, v18, v121
v_fmac_f32 v74, v20, v89
v_fmac_f32 v106, v20, v121
v_fmac_f32 v90, v19, v73
v_fmac_f32 v122, v19, v105
buffer_load_dwordx4 v15, s[36:39], s67 offen offset:1024 lds
v_fmac_f32 v75, v18, v74
v_fmac_f32 v107, v18, v106
v_fmac_f32 v91, v18, v90
v_fmac_f32 v123, v18, v122
v_fmac_f32 v75, v20, v90
v_fmac_f32 v107, v20, v122
v_fmac_f32 v91, v19, v74
v_fmac_f32 v123, v19, v106
v_fmac_f32 v76, v18, v75
v_fmac_f32 v108, v18, v107
v_fmac_f32 v92, v18, v91
v_fmac_f32 v124, v18, v123
v_fmac_f32 v76, v20, v91
v_fmac_f32 v108, v20, v123
v_fmac_f32 v92, v19, v75
v_fmac_f32 v124, v19, v107
buffer_load_dwordx4 v16, s[36:39], s67 offen offset:2048 lds
v_fmac_f32 v77, v18, v76
v_fmac_f32 v109, v18, v108
v_fmac_f32 v93, v18, v92
v_fmac_f32 v125, v18, v124
v_fmac_f32 v77, v20, v92
v_fmac_f32 v109, v20, v124
v_fmac_f32 v93, v19, v76
v_fmac_f32 v125, v19, v108
v_fmac_f32 v78, v18, v77
v_fmac_f32 v110, v18, v109
v_fmac_f32 v94, v18, v93
v_fmac_f32 v126, v18, v125
v_fmac_f32 v78, v20, v93
v_fmac_f32 v110, v20, v125
v_fmac_f32 v94, v19, v77
v_fmac_f32 v126, v19, v109
buffer_load_dwordx4 v17, s[36:39], s67 offen offset:3072 lds
v_fmac_f32 v79, v18, v78
v_fmac_f32 v111, v18, v110
v_fmac_f32 v95, v18, v94
v_fmac_f32 v127, v18, v126
v_fmac_f32 v79, v20, v94
v_fmac_f32 v111, v20, v126
v_fmac_f32 v95, v19, v78
v_fmac_f32 v127, v19, v110
s_mul_i32 s73, s5, 229376
s_add_u32 s73, s73, 4194304
s_lshl_b32 s60, s6, 1
s_add_u32 s59, s60, s58
s_lshl_b32 s59, s59, 14
s_lshl_b32 s60, s57, 13
s_add_u32 s59, s59, s60
s_add_u32 s59, s59, s73
v_lshrrev_b32 v226, 5, v1
v_lshlrev_b32 v226, 12, v226
v_xor_b32 v228, 0, v29
v_lshl_add_u32 v228, v228, 4, v226
v_cvt_pk_bf16_f32 v128, v64, v65
v_cvt_pk_bf16_f32 v129, v66, v67
v_cvt_pk_bf16_f32 v130, v68, v69
v_cvt_pk_bf16_f32 v131, v70, v71
buffer_store_dwordx4 v[128:131], v228, s[48:51], s59 offen offset:0 sc1
v_cvt_pk_bf16_f32 v132, -v80, -v81
v_cvt_pk_bf16_f32 v133, -v82, -v83
v_cvt_pk_bf16_f32 v134, -v84, -v85
v_cvt_pk_bf16_f32 v135, -v86, -v87
buffer_store_dwordx4 v[132:135], v228, s[48:51], s59 offen offset:512 sc1
v_xor_b32 v229, 4, v29
v_lshl_add_u32 v229, v229, 4, v226
v_cvt_pk_bf16_f32 v136, v72, v73
v_cvt_pk_bf16_f32 v137, v74, v75
v_cvt_pk_bf16_f32 v138, v76, v77
v_cvt_pk_bf16_f32 v139, v78, v79
buffer_store_dwordx4 v[136:139], v229, s[48:51], s59 offen offset:1024 sc1
v_cvt_pk_bf16_f32 v140, -v88, -v89
v_cvt_pk_bf16_f32 v141, -v90, -v91
v_cvt_pk_bf16_f32 v142, -v92, -v93
v_cvt_pk_bf16_f32 v143, -v94, -v95
buffer_store_dwordx4 v[140:143], v229, s[48:51], s59 offen offset:1536 sc1
v_xor_b32 v230, 8, v29
v_lshl_add_u32 v230, v230, 4, v226
v_cvt_pk_bf16_f32 v144, v96, v97
v_cvt_pk_bf16_f32 v145, v98, v99
v_cvt_pk_bf16_f32 v146, v100, v101
v_cvt_pk_bf16_f32 v147, v102, v103
buffer_store_dwordx4 v[144:147], v230, s[48:51], s59 offen offset:2048 sc1
v_cvt_pk_bf16_f32 v148, -v112, -v113
v_cvt_pk_bf16_f32 v149, -v114, -v115
v_cvt_pk_bf16_f32 v150, -v116, -v117
v_cvt_pk_bf16_f32 v151, -v118, -v119
buffer_store_dwordx4 v[148:151], v230, s[48:51], s59 offen offset:2560 sc1
v_xor_b32 v231, 12, v29
v_lshl_add_u32 v231, v231, 4, v226
v_cvt_pk_bf16_f32 v152, v104, v105
v_cvt_pk_bf16_f32 v153, v106, v107
v_cvt_pk_bf16_f32 v154, v108, v109
v_cvt_pk_bf16_f32 v155, v110, v111
buffer_store_dwordx4 v[152:155], v231, s[48:51], s59 offen offset:3072 sc1
v_cvt_pk_bf16_f32 v156, -v120, -v121
v_cvt_pk_bf16_f32 v157, -v122, -v123
v_cvt_pk_bf16_f32 v158, -v124, -v125
v_cvt_pk_bf16_f32 v159, -v126, -v127
buffer_store_dwordx4 v[156:159], v231, s[48:51], s59 offen offset:3584 sc1
s_add_u32 m0, s56, 98304
s_add_u32 s67, s6, 6
s_cmp_ge_u32 s67, 7
s_cselect_b32 s60, 7, 0
s_sub_u32 s67, s67, s60
s_lshl_b32 s67, s67, 7
s_add_u32 s67, s67, s75
buffer_load_dwordx4 v14, s[36:39], s67 offen offset:0 lds
buffer_load_dwordx4 v15, s[36:39], s67 offen offset:1024 lds
buffer_load_dwordx4 v16, s[36:39], s67 offen offset:2048 lds
buffer_load_dwordx4 v17, s[36:39], s67 offen offset:3072 lds
s_add_u32 m0, s56, 114688
s_lshl_b32 s67, s6, 7
s_add_u32 s67, s67, s54
buffer_load_dwordx4 v10, s[40:43], s67 offen offset:0 lds
buffer_load_dwordx4 v11, s[40:43], s67 offen offset:1024 lds
buffer_load_dwordx4 v12, s[40:43], s67 offen offset:2048 lds
buffer_load_dwordx4 v13, s[40:43], s67 offen offset:3072 lds
s_lshl_b32 s59, s58, 1
v_lshrrev_b32 v200, 5, v1
v_add_u32 v200, s59, v200
v_add_u32 v200, s59, v200
v_bfe_u32 v201, v1, 1, 3
v_lshlrev_b32 v202, 7, v29
s_lshl_b32 s60, s57, 13
s_add_u32 s60, s60, 114688
v_add_u32 v203, 0, v200
v_xor_b32 v203, v203, v201
v_lshl_add_u32 v203, v203, 4, v202
v_add_u32 v6, s60, v203
v_add_u32 v203, 2, v200
v_xor_b32 v203, v203, v201
v_lshl_add_u32 v203, v203, 4, v202
v_add_u32 v7, s60, v203
v_and_b32 v200, 1, v1
v_lshlrev_b32 v200, 4, v200
v_lshlrev_b32 v201, v200, v240
v_bfe_u32 v202, v1, 1, 2
v_bfe_u32 v203, v1, 4, 1
v_lshl_add_u32 v202, v203, 2, v202
v_bfe_u32 v203, v1, 3, 1
v_lshrrev_b32 v204, 5, v1
v_xor_b32 v203, v203, v204
v_lshl_add_u32 v202, v203, 3, v202
v_cmp_eq_u32 vcc, 0, v202
s_nop 1
v_cndmask_b32 v96, 0, v201, vcc
v_cmp_eq_u32 vcc, 1, v202
s_nop 1
v_cndmask_b32 v97, 0, v201, vcc
v_cmp_eq_u32 vcc, 2, v202
s_nop 1
v_cndmask_b32 v98, 0, v201, vcc
v_cmp_eq_u32 vcc, 3, v202
s_nop 1
v_cndmask_b32 v99, 0, v201, vcc
v_cmp_eq_u32 vcc, 4, v202
s_nop 1
v_cndmask_b32 v100, 0, v201, vcc
v_cmp_eq_u32 vcc, 5, v202
s_nop 1
v_cndmask_b32 v101, 0, v201, vcc
v_cmp_eq_u32 vcc, 6, v202
s_nop 1
v_cndmask_b32 v102, 0, v201, vcc
v_cmp_eq_u32 vcc, 7, v202
s_nop 1
v_cndmask_b32 v103, 0, v201, vcc
v_lshrrev_b32 v14, 4, v1
v_bfe_u32 v15, v1, 2, 2
v_and_b32 v16, 3, v1
v_and_b32 v17, 1, v14
v_lshlrev_b32 v17, 1, v17
v_lshrrev_b32 v18, 1, v16
v_add_u32 v17, v17, v18
v_lshrrev_b32 v18, 1, v14
v_lshl_add_u32 v18, v18, 3, v15
v_lshlrev_b32 v19, 2, v17
v_and_b32 v16, 1, v16
v_lshlrev_b32 v16, 3, v16
v_lshl_add_u32 v16, v17, 10, v16
s_lshl_b32 s59, s57, 13
v_add_u32 v16, s59, v16
v_add_u32 v21, 0, v18
v_xor_b32 v21, v21, v19
v_lshl_add_u32 v10, v21, 4, v16
v_add_u32 v12, 0x10000, v10
v_add_u32 v21, 4, v18
v_xor_b32 v21, v21, v19
v_lshl_add_u32 v11, v21, 4, v16
v_add_u32 v13, 0x10000, v11
v_lshrrev_b32 v20, 5, v1
v_mul_u32_u24 v20, 14336, v20
v_lshl_add_u32 v20, v29, 2, v20
s_lshl_b32 s60, s5, 7
s_lshl_b32 s61, s57, 6
s_add_u32 s60, s60, s61
s_mul_i32 s74, s60, 3584
s_lshl_b32 s59, s6, 8
s_add_u32 s74, s74, s59
s_lshl_b32 s59, s58, 7
s_add_u32 s74, s74, s59
v_lshrrev_b32 v200, 5, v1
v_bfe_u32 v201, v1, 1, 3
v_lshlrev_b32 v202, 7, v29
s_lshl_b32 s59, s58, 12
v_add_u32 v203, 0, v200
v_xor_b32 v203, v203, v201
v_lshl_add_u32 v203, v203, 4, v202
v_add_u32 v208, s59, v203
v_add_u32 v212, 0x10000, v208
v_add_u32 v203, 2, v200
v_xor_b32 v203, v203, v201
v_lshl_add_u32 v203, v203, 4, v202
v_add_u32 v209, s59, v203
v_add_u32 v213, 0x10000, v209
v_add_u32 v203, 4, v200
v_xor_b32 v203, v203, v201
v_lshl_add_u32 v203, v203, 4, v202
v_add_u32 v210, s59, v203
v_add_u32 v214, 0x10000, v210
v_add_u32 v203, 6, v200
v_xor_b32 v203, v203, v201
v_lshl_add_u32 v203, v203, 4, v202
v_add_u32 v211, s59, v203
v_add_u32 v215, 0x10000, v211
v_min_u32 v238, 6, v1
v_lshlrev_b32 v238, 7, v238
s_lshl_b32 s77, s5, 10
s_add_u32 s77, s77, 196608
s_waitcnt vmcnt(8)
s_barrier
s_cmp_eq_u32 s4, 0
s_cbranch_scc0 L_nofl_54
s_lshl_b32 s59, s6, 7
v_mov_b32 v205, s59
v_mov_b32 v206, s52
s_mov_b64 exec, 1
buffer_store_dword v206, v205, s[48:51], s77 offen sc1
s_mov_b64 exec, -1
L_nofl_54:
s_lshl_b32 s60, s6, 1
s_add_u32 s59, s60, s58
s_lshl_b32 s59, s59, 14
s_lshl_b32 s60, s57, 13
s_add_u32 s59, s59, s60
s_add_u32 s59, s59, s73
v_lshlrev_b32 v253, 7, v1
buffer_load_dword v254, v253, s[48:51], s59 offen sc1
ds_read_b128 a[0:3], v208 offset:0
ds_read_b128 a[4:7], v209 offset:0
ds_read_b128 a[8:11], v208 offset:8192
ds_read_b128 a[12:15], v209 offset:8192
ds_read_b128 a[16:19], v210 offset:0
ds_read_b128 a[20:23], v211 offset:0
ds_read_b128 a[24:27], v210 offset:8192
ds_read_b128 a[28:31], v211 offset:8192
ds_read_b128 a[32:35], v208 offset:16384
ds_read_b128 a[36:39], v209 offset:16384
ds_read_b128 a[40:43], v208 offset:24576
ds_read_b128 a[44:47], v209 offset:24576
ds_read_b128 a[48:51], v210 offset:16384
ds_read_b128 a[52:55], v211 offset:16384
ds_read_b128 a[56:59], v210 offset:24576
ds_read_b128 a[60:63], v211 offset:24576
ds_read_b128 a[64:67], v208 offset:32768
ds_read_b128 a[68:71], v209 offset:32768
ds_read_b128 a[72:75], v208 offset:40960
ds_read_b128 a[76:79], v209 offset:40960
ds_read_b128 a[80:83], v210 offset:32768
ds_read_b128 a[84:87], v211 offset:32768
ds_read_b128 a[88:91], v210 offset:40960
ds_read_b128 a[92:95], v211 offset:40960
ds_read_b128 a[96:99], v208 offset:49152
ds_read_b128 a[100:103], v209 offset:49152
ds_read_b128 a[104:107], v208 offset:57344
ds_read_b128 a[108:111], v209 offset:57344
ds_read_b128 a[112:115], v210 offset:49152
ds_read_b128 a[116:119], v211 offset:49152
ds_read_b128 a[120:123], v210 offset:57344
ds_read_b128 a[124:127], v211 offset:57344
ds_read_b128 a[128:131], v212 offset:0
ds_read_b128 a[132:135], v213 offset:0
ds_read_b128 a[136:139], v212 offset:8192
ds_read_b128 a[140:143], v213 offset:8192
ds_read_b128 a[144:147], v214 offset:0
ds_read_b128 a[148:151], v215 offset:0
ds_read_b128 a[152:155], v214 offset:8192
ds_read_b128 a[156:159], v215 offset:8192
ds_read_b128 a[160:163], v212 offset:16384
ds_read_b128 a[164:167], v213 offset:16384
ds_read_b128 a[168:171], v212 offset:24576
ds_read_b128 a[172:175], v213 offset:24576
ds_read_b128 a[176:179], v214 offset:16384
ds_read_b128 a[180:183], v215 offset:16384
ds_read_b128 a[184:187], v214 offset:24576
ds_read_b128 a[188:191], v215 offset:24576
s_waitcnt vmcnt(0)
s_barrier
ds_read_b128 v[64:67], v6 offset:0
ds_read_b128 v[68:71], v6 offset:4096
ds_read_b128 v[72:75], v7 offset:0
ds_read_b128 v[76:79], v7 offset:4096
ds_read_b128 a[192:195], v212 offset:32768
ds_read_b128 a[196:199], v213 offset:32768
ds_read_b128 a[200:203], v212 offset:40960
ds_read_b128 a[204:207], v213 offset:40960
ds_read_b128 a[208:211], v214 offset:32768
ds_read_b128 a[212:215], v215 offset:32768
ds_read_b128 a[216:219], v214 offset:40960
ds_read_b128 a[220:223], v215 offset:40960
s_waitcnt lgkmcnt(8)
v_mfma_f32_32x32x16_bf16 v[32:47], v[64:67], v[96:99], 0
v_mfma_f32_32x32x16_bf16 v[48:63], v[68:71], v[96:99], 0
v_mfma_f32_32x32x16_bf16 v[32:47], v[72:75], v[100:103], v[32:47]
v_mfma_f32_32x32x16_bf16 v[48:63], v[76:79], v[100:103], v[48:63]
s_waitcnt vmcnt(0) lgkmcnt(0)
s_barrier
s_lshl_b32 s72, s6, 1
s_add_u32 s73, s73, s56
buffer_load_dword v239, v238, s[48:51], s77 offen sc1
s_add_u32 m0, s56, 0
s_lshl_b32 s67, s72, 14
s_add_u32 s67, s67, s73
buffer_load_dwordx4 v4, s[48:51], s67 offen offset:0 sc1 lds
buffer_load_dwordx4 v4, s[48:51], s67 offen offset:1024 sc1 lds
buffer_load_dwordx4 v4, s[48:51], s67 offen offset:2048 sc1 lds
buffer_load_dwordx4 v4, s[48:51], s67 offen offset:3072 sc1 lds
s_add_u32 s72, s72, 1
s_cmp_ge_u32 s72, 14
s_cselect_b32 s60, 14, 0
s_sub_u32 s72, s72, s60
s_add_u32 m0, s56, 16384
s_lshl_b32 s67, s72, 14
s_add_u32 s67, s67, s73
buffer_load_dwordx4 v4, s[48:51], s67 offen offset:0 sc1 lds
buffer_load_dwordx4 v4, s[48:51], s67 offen offset:1024 sc1 lds
buffer_load_dwordx4 v4, s[48:51], s67 offen offset:2048 sc1 lds
buffer_load_dwordx4 v4, s[48:51], s67 offen offset:3072 sc1 lds
s_add_u32 s72, s72, 1
s_cmp_ge_u32 s72, 14
s_cselect_b32 s60, 14, 0
s_sub_u32 s72, s72, s60
s_waitcnt vmcnt(8)
s_mov_b32 s63, 0
s_branch L_flc_57
L_fl_55:
buffer_load_dword v239, v238, s[48:51], s77 offen sc1
s_waitcnt vmcnt(0)
L_flc_57:
v_cmp_ne_u32 vcc, s52, v239
s_add_u32 s63, s63, 1
s_cmp_lt_u32 s63, 1048576
s_cbranch_scc0 L_fld_56
s_cbranch_vccnz L_fl_55
L_fld_56:
s_cmp_eq_u32 s5, 15
s_cbranch_scc0 L_noep_58
s_cmp_eq_u32 s6, 0
s_cbranch_scc0 L_noep_58
s_cmp_eq_u32 s4, 0
s_cbranch_scc0 L_noep_58
v_mov_b32 v205, 0
v_mov_b32 v206, s52
s_mov_b64 exec, 1
buffer_store_dword v206, v205, s[48:51], 0 offen offset:0 sc1
s_mov_b64 exec, -1
s_waitcnt vmcnt(0)
L_noep_58:
s_add_u32 m0, s56, 32768
s_lshl_b32 s67, s72, 14
s_add_u32 s67, s67, s73
buffer_load_dwordx4 v4, s[48:51], s67 offen offset:0 sc1 lds
buffer_load_dwordx4 v4, s[48:51], s67 offen offset:1024 sc1 lds
buffer_load_dwordx4 v4, s[48:51], s67 offen offset:2048 sc1 lds
buffer_load_dwordx4 v4, s[48:51], s67 offen offset:3072 sc1 lds
s_add_u32 s72, s72, 1
s_cmp_ge_u32 s72, 14
s_cselect_b32 s60, 14, 0
s_sub_u32 s72, s72, s60
s_add_u32 m0, s56, 49152
s_lshl_b32 s67, s72, 14
s_add_u32 s67, s67, s73
buffer_load_dwordx4 v4, s[48:51], s67 offen offset:0 sc1 lds
buffer_load_dwordx4 v4, s[48:51], s67 offen offset:1024 sc1 lds
buffer_load_dwordx4 v4, s[48:51], s67 offen offset:2048 sc1 lds
buffer_load_dwordx4 v4, s[48:51], s67 offen offset:3072 sc1 lds
s_add_u32 s72, s72, 1
s_cmp_ge_u32 s72, 14
s_cselect_b32 s60, 14, 0
s_sub_u32 s72, s72, s60
s_waitcnt vmcnt(8)
s_barrier
ds_read_b64_tr_b16 v[64:65], v10 offset:0
ds_read_b64_tr_b16 v[66:67], v11 offset:0
ds_read_b64_tr_b16 v[68:69], v10 offset:4096
ds_read_b64_tr_b16 v[70:71], v11 offset:4096
ds_read_b64_tr_b16 v[72:73], v10 offset:256
ds_read_b64_tr_b16 v[74:75], v11 offset:256
ds_read_b64_tr_b16 v[76:77], v10 offset:4352
ds_read_b64_tr_b16 v[78:79], v11 offset:4352
s_waitcnt lgkmcnt(0)
v_mfma_f32_32x32x16_bf16 v[32:47], v[64:67], a[0:3], v[32:47]
ds_read_b64_tr_b16 v[80:81], v10 offset:512
ds_read_b64_tr_b16 v[82:83], v11 offset:512
ds_read_b64_tr_b16 v[84:85], v10 offset:4608
ds_read_b64_tr_b16 v[86:87], v11 offset:4608
v_mfma_f32_32x32x16_bf16 v[48:63], v[68:71], a[0:3], v[48:63]
ds_read_b64_tr_b16 v[88:89], v10 offset:768
ds_read_b64_tr_b16 v[90:91], v11 offset:768
ds_read_b64_tr_b16 v[92:93], v10 offset:4864
ds_read_b64_tr_b16 v[94:95], v11 offset:4864
v_mfma_f32_32x32x16_bf16 v[32:47], v[72:75], a[4:7], v[32:47]
s_add_u32 m0, s56, 65536
s_lshl_b32 s67, s72, 14
s_add_u32 s67, s67, s73
buffer_load_dwordx4 v4, s[48:51], s67 offen offset:0 sc1 lds
buffer_load_dwordx4 v4, s[48:51], s67 offen offset:1024 sc1 lds
v_mfma_f32_32x32x16_bf16 v[48:63], v[76:79], a[4:7], v[48:63]
buffer_load_dwordx4 v4, s[48:51], s67 offen offset:2048 sc1 lds
s_waitcnt lgkmcnt(0)
v_mfma_f32_32x32x16_bf16 v[32:47], v[80:83], a[8:11], v[32:47]
ds_read_b64_tr_b16 v[64:65], v10 offset:16384
ds_read_b64_tr_b16 v[66:67], v11 offset:16384
ds_read_b64_tr_b16 v[68:69], v10 offset:20480
ds_read_b64_tr_b16 v[70:71], v11 offset:20480
v_mfma_f32_32x32x16_bf16 v[48:63], v[84:87], a[8:11], v[48:63]
ds_read_b64_tr_b16 v[72:73], v10 offset:16640
ds_read_b64_tr_b16 v[74:75], v11 offset:16640
ds_read_b64_tr_b16 v[76:77], v10 offset:20736
ds_read_b64_tr_b16 v[78:79], v11 offset:20736
v_mfma_f32_32x32x16_bf16 v[32:47], v[88:91], a[12:15], v[32:47]
buffer_load_dwordx4 v4, s[48:51], s67 offen offset:3072 sc1 lds
s_add_u32 s72, s72, 1
s_cmp_ge_u32 s72, 14
s_cselect_b32 s60, 14, 0
s_sub_u32 s72, s72, s60
s_add_u32 m0, s56, 81920
s_lshl_b32 s67, s72, 14
s_add_u32 s67, s67, s73
buffer_load_dwordx4 v4, s[48:51], s67 offen offset:0 sc1 lds
v_mfma_f32_32x32x16_bf16 v[48:63], v[92:95], a[12:15], v[48:63]
buffer_load_dwordx4 v4, s[48:51], s67 offen offset:1024 sc1 lds
s_waitcnt lgkmcnt(0)
v_mfma_f32_32x32x16_bf16 v[32:47], v[64:67], a[16:19], v[32:47]
ds_read_b64_tr_b16 v[80:81], v10 offset:16896
ds_read_b64_tr_b16 v[82:83], v11 offset:16896
ds_read_b64_tr_b16 v[84:85], v10 offset:20992
ds_read_b64_tr_b16 v[86:87], v11 offset:20992
v_mfma_f32_32x32x16_bf16 v[48:63], v[68:71], a[16:19], v[48:63]
ds_read_b64_tr_b16 v[88:89], v10 offset:17152
ds_read_b64_tr_b16 v[90:91], v11 offset:17152
ds_read_b64_tr_b16 v[92:93], v10 offset:21248
ds_read_b64_tr_b16 v[94:95], v11 offset:21248
v_mfma_f32_32x32x16_bf16 v[32:47], v[72:75], a[20:23], v[32:47]
buffer_load_dwordx4 v4, s[48:51], s67 offen offset:2048 sc1 lds
v_mfma_f32_32x32x16_bf16 v[48:63], v[76:79], a[20:23], v[48:63]
buffer_load_dwordx4 v4, s[48:51], s67 offen offset:3072 sc1 lds
s_add_u32 s72, s72, 1
s_cmp_ge_u32 s72, 14
s_cselect_b32 s60, 14, 0
s_sub_u32 s72, s72, s60
s_waitcnt lgkmcnt(0)
s_waitcnt vmcnt(8)
s_barrier
v_mfma_f32_32x32x16_bf16 v[32:47], v[80:83], a[24:27], v[32:47]
ds_read_b64_tr_b16 v[64:65], v10 offset:32768
ds_read_b64_tr_b16 v[66:67], v11 offset:32768
ds_read_b64_tr_b16 v[68:69], v10 offset:36864
ds_read_b64_tr_b16 v[70:71], v11 offset:36864
v_mfma_f32_32x32x16_bf16 v[48:63], v[84:87], a[24:27], v[48:63]
ds_read_b64_tr_b16 v[72:73], v10 offset:33024
ds_read_b64_tr_b16 v[74:75], v11 offset:33024
ds_read_b64_tr_b16 v[76:77], v10 offset:37120
ds_read_b64_tr_b16 v[78:79], v11 offset:37120
v_mfma_f32_32x32x16_bf16 v[32:47], v[88:91], a[28:31], v[32:47]
s_add_u32 m0, s56, 0
s_lshl_b32 s67, s72, 14
s_add_u32 s67, s67, s73
buffer_load_dwordx4 v4, s[48:51], s67 offen offset:0 sc1 lds
v_mfma_f32_32x32x16_bf16 v[48:63], v[92:95], a[28:31], v[48:63]
buffer_load_dwordx4 v4, s[48:51], s67 offen offset:1024 sc1 lds
s_waitcnt lgkmcnt(0)
v_mfma_f32_32x32x16_bf16 v[32:47], v[64:67], a[32:35], v[32:47]
ds_read_b64_tr_b16 v[80:81], v10 offset:33280
ds_read_b64_tr_b16 v[82:83], v11 offset:33280
ds_read_b64_tr_b16 v[84:85], v10 offset:37376
ds_read_b64_tr_b16 v[86:87], v11 offset:37376
v_mfma_f32_32x32x16_bf16 v[48:63], v[68:71], a[32:35], v[48:63]
ds_read_b64_tr_b16 v[88:89], v10 offset:33536
ds_read_b64_tr_b16 v[90:91], v11 offset:33536
ds_read_b64_tr_b16 v[92:93], v10 offset:37632
ds_read_b64_tr_b16 v[94:95], v11 offset:37632
v_mfma_f32_32x32x16_bf16 v[32:47], v[72:75], a[36:39], v[32:47]
buffer_load_dwordx4 v4, s[48:51], s67 offen offset:2048 sc1 lds
v_mfma_f32_32x32x16_bf16 v[48:63], v[76:79], a[36:39], v[48:63]
buffer_load_dwordx4 v4, s[48:51], s67 offen offset:3072 sc1 lds
s_add_u32 s72, s72, 1
s_cmp_ge_u32 s72, 14
s_cselect_b32 s60, 14, 0
s_sub_u32 s72, s72, s60
s_waitcnt lgkmcnt(0)
v_mfma_f32_32x32x16_bf16 v[32:47], v[80:83], a[40:43], v[32:47]
ds_read_b64_tr_b16 v[64:65], v10 offset:49152
ds_read_b64_tr_b16 v[66:67], v11 offset:49152
ds_read_b64_tr_b16 v[68:69], v10 offset:53248
ds_read_b64_tr_b16 v[70:71], v11 offset:53248
v_mfma_f32_32x32x16_bf16 v[48:63], v[84:87], a[40:43], v[48:63]
ds_read_b64_tr_b16 v[72:73], v10 offset:49408
ds_read_b64_tr_b16 v[74:75], v11 offset:49408
ds_read_b64_tr_b16 v[76:77], v10 offset:53504
ds_read_b64_tr_b16 v[78:79], v11 offset:53504
v_mfma_f32_32x32x16_bf16 v[32:47], v[88:91], a[44:47], v[32:47]
s_add_u32 m0, s56, 16384
s_lshl_b32 s67, s72, 14
s_add_u32 s67, s67, s73
buffer_load_dwordx4 v4, s[48:51], s67 offen offset:0 sc1 lds
v_mfma_f32_32x32x16_bf16 v[48:63], v[92:95], a[44:47], v[48:63]
buffer_load_dwordx4 v4, s[48:51], s67 offen offset:1024 sc1 lds
s_waitcnt lgkmcnt(0)
v_mfma_f32_32x32x16_bf16 v[32:47], v[64:67], a[48:51], v[32:47]
ds_read_b64_tr_b16 v[80:81], v10 offset:49664
ds_read_b64_tr_b16 v[82:83], v11 offset:49664
ds_read_b64_tr_b16 v[84:85], v10 offset:53760
ds_read_b64_tr_b16 v[86:87], v11 offset:53760
v_mfma_f32_32x32x16_bf16 v[48:63], v[68:71], a[48:51], v[48:63]
ds_read_b64_tr_b16 v[88:89], v10 offset:49920
ds_read_b64_tr_b16 v[90:91], v11 offset:49920
ds_read_b64_tr_b16 v[92:93], v10 offset:54016
ds_read_b64_tr_b16 v[94:95], v11 offset:54016
v_mfma_f32_32x32x16_bf16 v[32:47], v[72:75], a[52:55], v[32:47]
buffer_load_dwordx4 v4, s[48:51], s67 offen offset:2048 sc1 lds
v_mfma_f32_32x32x16_bf16 v[48:63], v[76:79], a[52:55], v[48:63]
buffer_load_dwordx4 v4, s[48:51], s67 offen offset:3072 sc1 lds
s_add_u32 s72, s72, 1
s_cmp_ge_u32 s72, 14
s_cselect_b32 s60, 14, 0
s_sub_u32 s72, s72, s60
s_waitcnt lgkmcnt(0)
s_waitcnt vmcnt(8)
s_barrier
v_mfma_f32_32x32x16_bf16 v[32:47], v[80:83], a[56:59], v[32:47]
ds_read_b64_tr_b16 v[64:65], v12 offset:0
ds_read_b64_tr_b16 v[66:67], v13 offset:0
ds_read_b64_tr_b16 v[68:69], v12 offset:4096
ds_read_b64_tr_b16 v[70:71], v13 offset:4096
v_mfma_f32_32x32x16_bf16 v[48:63], v[84:87], a[56:59], v[48:63]
ds_read_b64_tr_b16 v[72:73], v12 offset:256
ds_read_b64_tr_b16 v[74:75], v13 offset:256
ds_read_b64_tr_b16 v[76:77], v12 offset:4352
ds_read_b64_tr_b16 v[78:79], v13 offset:4352
v_mfma_f32_32x32x16_bf16 v[32:47], v[88:91], a[60:63], v[32:47]
s_add_u32 m0, s56, 32768
s_lshl_b32 s67, s72, 14
s_add_u32 s67, s67, s73
buffer_load_dwordx4 v4, s[48:51], s67 offen offset:0 sc1 lds
v_mfma_f32_32x32x16_bf16 v[48:63], v[92:95], a[60:63], v[48:63]
buffer_load_dwordx4 v4, s[48:51], s67 offen offset:1024 sc1 lds
s_waitcnt lgkmcnt(0)
v_mfma_f32_32x32x16_bf16 v[32:47], v[64:67], a[64:67], v[32:47]
ds_read_b64_tr_b16 v[80:81], v12 offset:512
ds_read_b64_tr_b16 v[82:83], v13 offset:512
ds_read_b64_tr_b16 v[84:85], v12 offset:4608
ds_read_b64_tr_b16 v[86:87], v13 offset:4608
v_mfma_f32_32x32x16_bf16 v[48:63], v[68:71], a[64:67], v[48:63]
ds_read_b64_tr_b16 v[88:89], v12 offset:768
ds_read_b64_tr_b16 v[90:91], v13 offset:768
ds_read_b64_tr_b16 v[92:93], v12 offset:4864
ds_read_b64_tr_b16 v[94:95], v13 offset:4864
v_mfma_f32_32x32x16_bf16 v[32:47], v[72:75], a[68:71], v[32:47]
buffer_load_dwordx4 v4, s[48:51], s67 offen offset:2048 sc1 lds
v_mfma_f32_32x32x16_bf16 v[48:63], v[76:79], a[68:71], v[48:63]
buffer_load_dwordx4 v4, s[48:51], s67 offen offset:3072 sc1 lds
s_add_u32 s72, s72, 1
s_cmp_ge_u32 s72, 14
s_cselect_b32 s60, 14, 0
s_sub_u32 s72, s72, s60
s_waitcnt lgkmcnt(0)
v_mfma_f32_32x32x16_bf16 v[32:47], v[80:83], a[72:75], v[32:47]
ds_read_b64_tr_b16 v[64:65], v12 offset:16384
ds_read_b64_tr_b16 v[66:67], v13 offset:16384
ds_read_b64_tr_b16 v[68:69], v12 offset:20480
ds_read_b64_tr_b16 v[70:71], v13 offset:20480
v_mfma_f32_32x32x16_bf16 v[48:63], v[84:87], a[72:75], v[48:63]
ds_read_b64_tr_b16 v[72:73], v12 offset:16640
ds_read_b64_tr_b16 v[74:75], v13 offset:16640
ds_read_b64_tr_b16 v[76:77], v12 offset:20736
ds_read_b64_tr_b16 v[78:79], v13 offset:20736
v_mfma_f32_32x32x16_bf16 v[32:47], v[88:91], a[76:79], v[32:47]
s_add_u32 m0, s56, 49152
s_lshl_b32 s67, s72, 14
s_add_u32 s67, s67, s73
buffer_load_dwordx4 v4, s[48:51], s67 offen offset:0 sc1 lds
v_mfma_f32_32x32x16_bf16 v[48:63], v[92:95], a[76:79], v[48:63]
buffer_load_dwordx4 v4, s[48:51], s67 offen offset:1024 sc1 lds
s_waitcnt lgkmcnt(0)
v_mfma_f32_32x32x16_bf16 v[32:47], v[64:67], a[80:83], v[32:47]
ds_read_b64_tr_b16 v[80:81], v12 offset:16896
ds_read_b64_tr_b16 v[82:83], v13 offset:16896
ds_read_b64_tr_b16 v[84:85], v12 offset:20992
ds_read_b64_tr_b16 v[86:87], v13 offset:20992
v_mfma_f32_32x32x16_bf16 v[48:63], v[68:71], a[80:83], v[48:63]
ds_read_b64_tr_b16 v[88:89], v12 offset:17152
ds_read_b64_tr_b16 v[90:91], v13 offset:17152
ds_read_b64_tr_b16 v[92:93], v12 offset:21248
ds_read_b64_tr_b16 v[94:95], v13 offset:21248
v_mfma_f32_32x32x16_bf16 v[32:47], v[72:75], a[84:87], v[32:47]
buffer_load_dwordx4 v4, s[48:51], s67 offen offset:2048 sc1 lds
v_mfma_f32_32x32x16_bf16 v[48:63], v[76:79], a[84:87], v[48:63]
buffer_load_dwordx4 v4, s[48:51], s67 offen offset:3072 sc1 lds
s_add_u32 s72, s72, 1
s_cmp_ge_u32 s72, 14
s_cselect_b32 s60, 14, 0
s_sub_u32 s72, s72, s60
s_waitcnt lgkmcnt(0)
s_waitcnt vmcnt(8)
s_barrier
v_mfma_f32_32x32x16_bf16 v[32:47], v[80:83], a[88:91], v[32:47]
ds_read_b64_tr_b16 v[64:65], v10 offset:0
ds_read_b64_tr_b16 v[66:67], v11 offset:0
ds_read_b64_tr_b16 v[68:69], v10 offset:4096
ds_read_b64_tr_b16 v[70:71], v11 offset:4096
v_mfma_f32_32x32x16_bf16 v[48:63], v[84:87], a[88:91], v[48:63]
ds_read_b64_tr_b16 v[72:73], v10 offset:256
ds_read_b64_tr_b16 v[74:75], v11 offset:256
ds_read_b64_tr_b16 v[76:77], v10 offset:4352
ds_read_b64_tr_b16 v[78:79], v11 offset:4352
v_mfma_f32_32x32x16_bf16 v[32:47], v[88:91], a[92:95], v[32:47]
s_add_u32 m0, s56, 65536
s_lshl_b32 s67, s72, 14
s_add_u32 s67, s67, s73
buffer_load_dwordx4 v4, s[48:51], s67 offen offset:0 sc1 lds
v_mfma_f32_32x32x16_bf16 v[48:63], v[92:95], a[92:95], v[48:63]
buffer_load_dwordx4 v4, s[48:51], s67 offen offset:1024 sc1 lds
s_waitcnt lgkmcnt(0)
v_mfma_f32_32x32x16_bf16 v[32:47], v[64:67], a[96:99], v[32:47]
ds_read_b64_tr_b16 v[80:81], v10 offset:512
ds_read_b64_tr_b16 v[82:83], v11 offset:512
ds_read_b64_tr_b16 v[84:85], v10 offset:4608
ds_read_b64_tr_b16 v[86:87], v11 offset:4608
v_mfma_f32_32x32x16_bf16 v[48:63], v[68:71], a[96:99], v[48:63]
ds_read_b64_tr_b16 v[88:89], v10 offset:768
ds_read_b64_tr_b16 v[90:91], v11 offset:768
ds_read_b64_tr_b16 v[92:93], v10 offset:4864
ds_read_b64_tr_b16 v[94:95], v11 offset:4864
v_mfma_f32_32x32x16_bf16 v[32:47], v[72:75], a[100:103], v[32:47]
buffer_load_dwordx4 v4, s[48:51], s67 offen offset:2048 sc1 lds
v_mfma_f32_32x32x16_bf16 v[48:63], v[76:79], a[100:103], v[48:63]
buffer_load_dwordx4 v4, s[48:51], s67 offen offset:3072 sc1 lds
s_add_u32 s72, s72, 1
s_cmp_ge_u32 s72, 14
s_cselect_b32 s60, 14, 0
s_sub_u32 s72, s72, s60
s_waitcnt lgkmcnt(0)
v_mfma_f32_32x32x16_bf16 v[32:47], v[80:83], a[104:107], v[32:47]
ds_read_b64_tr_b16 v[64:65], v10 offset:16384
ds_read_b64_tr_b16 v[66:67], v11 offset:16384
ds_read_b64_tr_b16 v[68:69], v10 offset:20480
ds_read_b64_tr_b16 v[70:71], v11 offset:20480
v_mfma_f32_32x32x16_bf16 v[48:63], v[84:87], a[104:107], v[48:63]
ds_read_b64_tr_b16 v[72:73], v10 offset:16640
ds_read_b64_tr_b16 v[74:75], v11 offset:16640
ds_read_b64_tr_b16 v[76:77], v10 offset:20736
ds_read_b64_tr_b16 v[78:79], v11 offset:20736
v_mfma_f32_32x32x16_bf16 v[32:47], v[88:91], a[108:111], v[32:47]
s_add_u32 m0, s56, 81920
s_lshl_b32 s67, s72, 14
s_add_u32 s67, s67, s73
buffer_load_dwordx4 v4, s[48:51], s67 offen offset:0 sc1 lds
v_mfma_f32_32x32x16_bf16 v[48:63], v[92:95], a[108:111], v[48:63]
buffer_load_dwordx4 v4, s[48:51], s67 offen offset:1024 sc1 lds
s_waitcnt lgkmcnt(0)
v_mfma_f32_32x32x16_bf16 v[32:47], v[64:67], a[112:115], v[32:47]
ds_read_b64_tr_b16 v[80:81], v10 offset:16896
ds_read_b64_tr_b16 v[82:83], v11 offset:16896
ds_read_b64_tr_b16 v[84:85], v10 offset:20992
ds_read_b64_tr_b16 v[86:87], v11 offset:20992
v_mfma_f32_32x32x16_bf16 v[48:63], v[68:71], a[112:115], v[48:63]
ds_read_b64_tr_b16 v[88:89], v10 offset:17152
ds_read_b64_tr_b16 v[90:91], v11 offset:17152
ds_read_b64_tr_b16 v[92:93], v10 offset:21248
ds_read_b64_tr_b16 v[94:95], v11 offset:21248
v_mfma_f32_32x32x16_bf16 v[32:47], v[72:75], a[116:119], v[32:47]
buffer_load_dwordx4 v4, s[48:51], s67 offen offset:2048 sc1 lds
v_mfma_f32_32x32x16_bf16 v[48:63], v[76:79], a[116:119], v[48:63]
buffer_load_dwordx4 v4, s[48:51], s67 offen offset:3072 sc1 lds
s_add_u32 s72, s72, 1
s_cmp_ge_u32 s72, 14
s_cselect_b32 s60, 14, 0
s_sub_u32 s72, s72, s60
s_waitcnt lgkmcnt(0)
s_waitcnt vmcnt(8)
s_barrier
v_mfma_f32_32x32x16_bf16 v[32:47], v[80:83], a[120:123], v[32:47]
ds_read_b64_tr_b16 v[64:65], v10 offset:32768
ds_read_b64_tr_b16 v[66:67], v11 offset:32768
ds_read_b64_tr_b16 v[68:69], v10 offset:36864
ds_read_b64_tr_b16 v[70:71], v11 offset:36864
v_mfma_f32_32x32x16_bf16 v[48:63], v[84:87], a[120:123], v[48:63]
ds_read_b64_tr_b16 v[72:73], v10 offset:33024
ds_read_b64_tr_b16 v[74:75], v11 offset:33024
ds_read_b64_tr_b16 v[76:77], v10 offset:37120
ds_read_b64_tr_b16 v[78:79], v11 offset:37120
v_mfma_f32_32x32x16_bf16 v[32:47], v[88:91], a[124:127], v[32:47]
s_add_u32 m0, s56, 0
s_lshl_b32 s67, s72, 14
s_add_u32 s67, s67, s73
buffer_load_dwordx4 v4, s[48:51], s67 offen offset:0 sc1 lds
v_mfma_f32_32x32x16_bf16 v[48:63], v[92:95], a[124:127], v[48:63]
buffer_load_dwordx4 v4, s[48:51], s67 offen offset:1024 sc1 lds
s_waitcnt lgkmcnt(0)
v_mfma_f32_32x32x16_bf16 v[32:47], v[64:67], a[128:131], v[32:47]
ds_read_b64_tr_b16 v[80:81], v10 offset:33280
ds_read_b64_tr_b16 v[82:83], v11 offset:33280
ds_read_b64_tr_b16 v[84:85], v10 offset:37376
ds_read_b64_tr_b16 v[86:87], v11 offset:37376
v_mfma_f32_32x32x16_bf16 v[48:63], v[68:71], a[128:131], v[48:63]
ds_read_b64_tr_b16 v[88:89], v10 offset:33536
ds_read_b64_tr_b16 v[90:91], v11 offset:33536
ds_read_b64_tr_b16 v[92:93], v10 offset:37632
ds_read_b64_tr_b16 v[94:95], v11 offset:37632
v_mfma_f32_32x32x16_bf16 v[32:47], v[72:75], a[132:135], v[32:47]
buffer_load_dwordx4 v4, s[48:51], s67 offen offset:2048 sc1 lds
v_mfma_f32_32x32x16_bf16 v[48:63], v[76:79], a[132:135], v[48:63]
buffer_load_dwordx4 v4, s[48:51], s67 offen offset:3072 sc1 lds
s_add_u32 s72, s72, 1
s_cmp_ge_u32 s72, 14
s_cselect_b32 s60, 14, 0
s_sub_u32 s72, s72, s60
s_waitcnt lgkmcnt(0)
v_mfma_f32_32x32x16_bf16 v[32:47], v[80:83], a[136:139], v[32:47]
ds_read_b64_tr_b16 v[64:65], v10 offset:49152
ds_read_b64_tr_b16 v[66:67], v11 offset:49152
ds_read_b64_tr_b16 v[68:69], v10 offset:53248
ds_read_b64_tr_b16 v[70:71], v11 offset:53248
v_mfma_f32_32x32x16_bf16 v[48:63], v[84:87], a[136:139], v[48:63]
ds_read_b64_tr_b16 v[72:73], v10 offset:49408
ds_read_b64_tr_b16 v[74:75], v11 offset:49408
ds_read_b64_tr_b16 v[76:77], v10 offset:53504
ds_read_b64_tr_b16 v[78:79], v11 offset:53504
v_mfma_f32_32x32x16_bf16 v[32:47], v[88:91], a[140:143], v[32:47]
s_add_u32 m0, s56, 16384
s_lshl_b32 s67, s72, 14
s_add_u32 s67, s67, s73
buffer_load_dwordx4 v4, s[48:51], s67 offen offset:0 sc1 lds
v_mfma_f32_32x32x16_bf16 v[48:63], v[92:95], a[140:143], v[48:63]
buffer_load_dwordx4 v4, s[48:51], s67 offen offset:1024 sc1 lds
s_waitcnt lgkmcnt(0)
v_mfma_f32_32x32x16_bf16 v[32:47], v[64:67], a[144:147], v[32:47]
ds_read_b64_tr_b16 v[80:81], v10 offset:49664
ds_read_b64_tr_b16 v[82:83], v11 offset:49664
ds_read_b64_tr_b16 v[84:85], v10 offset:53760
ds_read_b64_tr_b16 v[86:87], v11 offset:53760
v_mfma_f32_32x32x16_bf16 v[48:63], v[68:71], a[144:147], v[48:63]
ds_read_b64_tr_b16 v[88:89], v10 offset:49920
ds_read_b64_tr_b16 v[90:91], v11 offset:49920
ds_read_b64_tr_b16 v[92:93], v10 offset:54016
ds_read_b64_tr_b16 v[94:95], v11 offset:54016
v_mfma_f32_32x32x16_bf16 v[32:47], v[72:75], a[148:151], v[32:47]
buffer_load_dwordx4 v4, s[48:51], s67 offen offset:2048 sc1 lds
v_mfma_f32_32x32x16_bf16 v[48:63], v[76:79], a[148:151], v[48:63]
buffer_load_dwordx4 v4, s[48:51], s67 offen offset:3072 sc1 lds
s_add_u32 s72, s72, 1
s_cmp_ge_u32 s72, 14
s_cselect_b32 s60, 14, 0
s_sub_u32 s72, s72, s60
s_waitcnt lgkmcnt(0)
s_waitcnt vmcnt(8)
s_barrier
v_mfma_f32_32x32x16_bf16 v[32:47], v[80:83], a[152:155], v[32:47]
ds_read_b64_tr_b16 v[64:65], v12 offset:0
ds_read_b64_tr_b16 v[66:67], v13 offset:0
ds_read_b64_tr_b16 v[68:69], v12 offset:4096
ds_read_b64_tr_b16 v[70:71], v13 offset:4096
v_mfma_f32_32x32x16_bf16 v[48:63], v[84:87], a[152:155], v[48:63]
ds_read_b64_tr_b16 v[72:73], v12 offset:256
ds_read_b64_tr_b16 v[74:75], v13 offset:256
ds_read_b64_tr_b16 v[76:77], v12 offset:4352
ds_read_b64_tr_b16 v[78:79], v13 offset:4352
v_mfma_f32_32x32x16_bf16 v[32:47], v[88:91], a[156:159], v[32:47]
v_mfma_f32_32x32x16_bf16 v[48:63], v[92:95], a[156:159], v[48:63]
s_waitcnt lgkmcnt(0)
v_mfma_f32_32x32x16_bf16 v[32:47], v[64:67], a[160:163], v[32:47]
ds_read_b64_tr_b16 v[80:81], v12 offset:512
ds_read_b64_tr_b16 v[82:83], v13 offset:512
ds_read_b64_tr_b16 v[84:85], v12 offset:4608
ds_read_b64_tr_b16 v[86:87], v13 offset:4608
v_mfma_f32_32x32x16_bf16 v[48:63], v[68:71], a[160:163], v[48:63]
ds_read_b64_tr_b16 v[88:89], v12 offset:768
ds_read_b64_tr_b16 v[90:91], v13 offset:768
ds_read_b64_tr_b16 v[92:93], v12 offset:4864
ds_read_b64_tr_b16 v[94:95], v13 offset:4864
v_mfma_f32_32x32x16_bf16 v[32:47], v[72:75], a[164:167], v[32:47]
v_mfma_f32_32x32x16_bf16 v[48:63], v[76:79], a[164:167], v[48:63]
s_waitcnt lgkmcnt(0)
v_mfma_f32_32x32x16_bf16 v[32:47], v[80:83], a[168:171], v[32:47]
ds_read_b64_tr_b16 v[64:65], v12 offset:16384
ds_read_b64_tr_b16 v[66:67], v13 offset:16384
ds_read_b64_tr_b16 v[68:69], v12 offset:20480
ds_read_b64_tr_b16 v[70:71], v13 offset:20480
v_mfma_f32_32x32x16_bf16 v[48:63], v[84:87], a[168:171], v[48:63]
ds_read_b64_tr_b16 v[72:73], v12 offset:16640
ds_read_b64_tr_b16 v[74:75], v13 offset:16640
ds_read_b64_tr_b16 v[76:77], v12 offset:20736
ds_read_b64_tr_b16 v[78:79], v13 offset:20736
v_mfma_f32_32x32x16_bf16 v[32:47], v[88:91], a[172:175], v[32:47]
v_mfma_f32_32x32x16_bf16 v[48:63], v[92:95], a[172:175], v[48:63]
s_waitcnt lgkmcnt(0)
v_mfma_f32_32x32x16_bf16 v[32:47], v[64:67], a[176:179], v[32:47]
ds_read_b64_tr_b16 v[80:81], v12 offset:16896
ds_read_b64_tr_b16 v[82:83], v13 offset:16896
ds_read_b64_tr_b16 v[84:85], v12 offset:20992
ds_read_b64_tr_b16 v[86:87], v13 offset:20992
v_mfma_f32_32x32x16_bf16 v[48:63], v[68:71], a[176:179], v[48:63]
ds_read_b64_tr_b16 v[88:89], v12 offset:17152
ds_read_b64_tr_b16 v[90:91], v13 offset:17152
ds_read_b64_tr_b16 v[92:93], v12 offset:21248
ds_read_b64_tr_b16 v[94:95], v13 offset:21248
v_mfma_f32_32x32x16_bf16 v[32:47], v[72:75], a[180:183], v[32:47]
v_mfma_f32_32x32x16_bf16 v[48:63], v[76:79], a[180:183], v[48:63]
s_waitcnt lgkmcnt(0)
s_waitcnt vmcnt(0)
s_barrier
v_mfma_f32_32x32x16_bf16 v[32:47], v[80:83], a[184:187], v[32:47]
ds_read_b64_tr_b16 v[64:65], v10 offset:0
ds_read_b64_tr_b16 v[66:67], v11 offset:0
ds_read_b64_tr_b16 v[68:69], v10 offset:4096
ds_read_b64_tr_b16 v[70:71], v11 offset:4096
v_mfma_f32_32x32x16_bf16 v[48:63], v[84:87], a[184:187], v[48:63]
ds_read_b64_tr_b16 v[72:73], v10 offset:256
ds_read_b64_tr_b16 v[74:75], v11 offset:256
ds_read_b64_tr_b16 v[76:77], v10 offset:4352
ds_read_b64_tr_b16 v[78:79], v11 offset:4352
v_mfma_f32_32x32x16_bf16 v[32:47], v[88:91], a[188:191], v[32:47]
v_mfma_f32_32x32x16_bf16 v[48:63], v[92:95], a[188:191], v[48:63]
s_waitcnt lgkmcnt(0)
v_mfma_f32_32x32x16_bf16 v[32:47], v[64:67], a[192:195], v[32:47]
ds_read_b64_tr_b16 v[80:81], v10 offset:512
ds_read_b64_tr_b16 v[82:83], v11 offset:512
ds_read_b64_tr_b16 v[84:85], v10 offset:4608
ds_read_b64_tr_b16 v[86:87], v11 offset:4608
v_mfma_f32_32x32x16_bf16 v[48:63], v[68:71], a[192:195], v[48:63]
ds_read_b64_tr_b16 v[88:89], v10 offset:768
ds_read_b64_tr_b16 v[90:91], v11 offset:768
ds_read_b64_tr_b16 v[92:93], v10 offset:4864
ds_read_b64_tr_b16 v[94:95], v11 offset:4864
v_mfma_f32_32x32x16_bf16 v[32:47], v[72:75], a[196:199], v[32:47]
v_mfma_f32_32x32x16_bf16 v[48:63], v[76:79], a[196:199], v[48:63]
s_waitcnt lgkmcnt(0)
v_mfma_f32_32x32x16_bf16 v[32:47], v[80:83], a[200:203], v[32:47]
ds_read_b64_tr_b16 v[64:65], v10 offset:16384
ds_read_b64_tr_b16 v[66:67], v11 offset:16384
ds_read_b64_tr_b16 v[68:69], v10 offset:20480
ds_read_b64_tr_b16 v[70:71], v11 offset:20480
v_mfma_f32_32x32x16_bf16 v[48:63], v[84:87], a[200:203], v[48:63]
ds_read_b64_tr_b16 v[72:73], v10 offset:16640
ds_read_b64_tr_b16 v[74:75], v11 offset:16640
ds_read_b64_tr_b16 v[76:77], v10 offset:20736
ds_read_b64_tr_b16 v[78:79], v11 offset:20736
v_mfma_f32_32x32x16_bf16 v[32:47], v[88:91], a[204:207], v[32:47]
v_mfma_f32_32x32x16_bf16 v[48:63], v[92:95], a[204:207], v[48:63]
s_waitcnt lgkmcnt(0)
v_mfma_f32_32x32x16_bf16 v[32:47], v[64:67], a[208:211], v[32:47]
ds_read_b64_tr_b16 v[80:81], v10 offset:16896
ds_read_b64_tr_b16 v[82:83], v11 offset:16896
ds_read_b64_tr_b16 v[84:85], v10 offset:20992
ds_read_b64_tr_b16 v[86:87], v11 offset:20992
v_mfma_f32_32x32x16_bf16 v[48:63], v[68:71], a[208:211], v[48:63]
ds_read_b64_tr_b16 v[88:89], v10 offset:17152
ds_read_b64_tr_b16 v[90:91], v11 offset:17152
ds_read_b64_tr_b16 v[92:93], v10 offset:21248
ds_read_b64_tr_b16 v[94:95], v11 offset:21248
v_mfma_f32_32x32x16_bf16 v[32:47], v[72:75], a[212:215], v[32:47]
v_mfma_f32_32x32x16_bf16 v[48:63], v[76:79], a[212:215], v[48:63]
s_waitcnt lgkmcnt(0)
v_mfma_f32_32x32x16_bf16 v[32:47], v[80:83], a[216:219], v[32:47]
v_mfma_f32_32x32x16_bf16 v[48:63], v[84:87], a[216:219], v[48:63]
v_mfma_f32_32x32x16_bf16 v[32:47], v[88:91], a[220:223], v[32:47]
v_mfma_f32_32x32x16_bf16 v[48:63], v[92:95], a[220:223], v[48:63]
s_nop 7
s_nop 3
s_add_u32 s59, s74, 0
buffer_store_dword v32, v20, s[68:71], s59 offen sc0 sc1
s_add_u32 s59, s74, 3584
buffer_store_dword v33, v20, s[68:71], s59 offen sc0 sc1
s_add_u32 s59, s74, 7168
buffer_store_dword v34, v20, s[68:71], s59 offen sc0 sc1
s_add_u32 s59, s74, 10752
buffer_store_dword v35, v20, s[68:71], s59 offen sc0 sc1
s_add_u32 s59, s74, 28672
buffer_store_dword v36, v20, s[68:71], s59 offen sc0 sc1
s_add_u32 s59, s74, 32256
buffer_store_dword v37, v20, s[68:71], s59 offen sc0 sc1
s_add_u32 s59, s74, 35840
buffer_store_dword v38, v20, s[68:71], s59 offen sc0 sc1
s_add_u32 s59, s74, 39424
buffer_store_dword v39, v20, s[68:71], s59 offen sc0 sc1
s_add_u32 s59, s74, 57344
buffer_store_dword v40, v20, s[68:71], s59 offen sc0 sc1
s_add_u32 s59, s74, 60928
buffer_store_dword v41, v20, s[68:71], s59 offen sc0 sc1
s_add_u32 s59, s74, 64512
buffer_store_dword v42, v20, s[68:71], s59 offen sc0 sc1
s_add_u32 s59, s74, 68096
buffer_store_dword v43, v20, s[68:71], s59 offen sc0 sc1
s_add_u32 s59, s74, 86016
buffer_store_dword v44, v20, s[68:71], s59 offen sc0 sc1
s_add_u32 s59, s74, 89600
buffer_store_dword v45, v20, s[68:71], s59 offen sc0 sc1
s_add_u32 s59, s74, 93184
buffer_store_dword v46, v20, s[68:71], s59 offen sc0 sc1
s_add_u32 s59, s74, 96768
buffer_store_dword v47, v20, s[68:71], s59 offen sc0 sc1
s_add_u32 s59, s74, 114688
buffer_store_dword v48, v20, s[68:71], s59 offen sc0 sc1
s_add_u32 s59, s74, 118272
buffer_store_dword v49, v20, s[68:71], s59 offen sc0 sc1
s_add_u32 s59, s74, 121856
buffer_store_dword v50, v20, s[68:71], s59 offen sc0 sc1
s_add_u32 s59, s74, 125440
buffer_store_dword v51, v20, s[68:71], s59 offen sc0 sc1
s_add_u32 s59, s74, 143360
buffer_store_dword v52, v20, s[68:71], s59 offen sc0 sc1
s_add_u32 s59, s74, 146944
buffer_store_dword v53, v20, s[68:71], s59 offen sc0 sc1
s_add_u32 s59, s74, 150528
buffer_store_dword v54, v20, s[68:71], s59 offen sc0 sc1
s_add_u32 s59, s74, 154112
buffer_store_dword v55, v20, s[68:71], s59 offen sc0 sc1
s_add_u32 s59, s74, 172032
buffer_store_dword v56, v20, s[68:71], s59 offen sc0 sc1
s_add_u32 s59, s74, 175616
buffer_store_dword v57, v20, s[68:71], s59 offen sc0 sc1
s_add_u32 s59, s74, 179200
buffer_store_dword v58, v20, s[68:71], s59 offen sc0 sc1
s_add_u32 s59, s74, 182784
buffer_store_dword v59, v20, s[68:71], s59 offen sc0 sc1
s_add_u32 s59, s74, 200704
buffer_store_dword v60, v20, s[68:71], s59 offen sc0 sc1
s_add_u32 s59, s74, 204288
buffer_store_dword v61, v20, s[68:71], s59 offen sc0 sc1
s_add_u32 s59, s74, 207872
buffer_store_dword v62, v20, s[68:71], s59 offen sc0 sc1
s_add_u32 s59, s74, 211456
buffer_store_dword v63, v20, s[68:71], s59 offen sc0 sc1
s_endpgm
L_exit:
s_endpgm
.fill 64, 4, 0xbf800000
.p2align 8
L_codeend:
.section .rodata,"a"
.p2align 6
.amdhsa_kernel concat_heads__ssm_conv_s5__linear_attn_block__prompt_kernel
  .amdhsa_next_free_vgpr 480
  .amdhsa_next_free_sgpr 102
  .amdhsa_accum_offset 256
  .amdhsa_group_segment_fixed_size 0
  .amdhsa_kernarg_size 120
  .amdhsa_user_sgpr_count 2
  .amdhsa_user_sgpr_kernarg_segment_ptr 1
  .amdhsa_system_sgpr_workgroup_id_x 1
  .amdhsa_float_denorm_mode_32 3
.end_amdhsa_kernel
```
